```python
import torch

def _softmax(x, axis=-1):
    return torch.softmax(x, dim=axis)
def _gelu(x):
    return torch.nn.functional.gelu(x, approximate="tanh")
def _silu(x):
    return torch.nn.functional.silu(x)
def _sigmoid(x):
    return torch.sigmoid(x)
def _layernorm(x, axis=-1, eps=1e-5):
    m = x.mean(dim=axis, keepdim=True)
    v = x.var(dim=axis, keepdim=True, unbiased=False)
    return (x - m) / torch.sqrt(v + eps)
def _scatter_add(tgt, idx, src, axis=0):
    return tgt.clone().index_add_(axis, idx, src)
def _segment_sum(src, seg, n):
    out = torch.zeros((n,) + src.shape[1:], dtype=src.dtype)
    return out.index_add_(0, seg, src)
def _pad(x, pw):
    flat = tuple(v for pair in reversed(pw) for v in pair)
    return torch.nn.functional.pad(x, flat)

kernel_name = 'parallel_sum__ssm_conv_h3__glu_gated_reglu__prompt'

def setup_inputs():

    _w = (lambda a: (lambda t: t.to(torch.bfloat16) if t.is_floating_point() else t)(torch.as_tensor(a)))
    def _A_setup():
        B, S, D = 1, 2048, 448
        ks = 4
        return {
            "q": _w((lambda *s: torch.randn(*s, dtype=torch.bfloat16) * 0.05)(B, S, D)),
            "k": _w((lambda *s: torch.randn(*s, dtype=torch.bfloat16) * 0.2)(B, S, D)),
            "v": _w((lambda *s: torch.randn(*s, dtype=torch.bfloat16) * 0.2)(B, S, D)),
            "shift_k": _w((lambda *s: torch.randn(*s, dtype=torch.bfloat16) * 0.2)(D, ks) * 0.5),
            "ssm_k": _w((lambda *s: torch.randn(*s, dtype=torch.bfloat16) * 0.4)(D, S) * (1.0 / S ** 0.5)),
            "ssm_D": _w((lambda *s: torch.randn(*s, dtype=torch.bfloat16) * 0.2)(D)),
        }
    _A_in = _A_setup()

    def _B_setup():
        B, S, D, F = 1, 2048, 448, 1792
        return {
            "x": _w((lambda *s: torch.randn(*s, dtype=torch.bfloat16) * 0.05)(B, S, D)),
            "W_gate": _w((lambda *s: torch.randn(*s, dtype=torch.bfloat16) * 0.2)(D, F) * (2.0 / D) ** 0.5),
            "W_up": _w((lambda *s: torch.randn(*s, dtype=torch.bfloat16) * 0.2)(D, F) * (2.0 / D) ** 0.5),
            "W_down": _w((lambda *s: torch.randn(*s, dtype=torch.bfloat16) * 0.2)(F, D) * (1.0 / F) ** 0.5),
        }
    _B_in = _B_setup()

    return {
        "A_q": _A_in["q"],
        "A_k": _A_in["k"],
        "A_v": _A_in["v"],
        "A_shift_k": _A_in["shift_k"],
        "A_ssm_k": _A_in["ssm_k"],
        "A_ssm_D": _A_in["ssm_D"],
        "B_x": _B_in["x"],
        "B_W_gate": _B_in["W_gate"],
        "B_W_up": _B_in["W_up"],
        "B_W_down": _B_in["W_down"],
    }

def reference(A_q, A_k, A_v, A_shift_k, A_ssm_k, A_ssm_D, B_x, B_W_gate, B_W_up, B_W_down):
    def _A_ref(q, k, v, shift_k, ssm_k, ssm_D):
        B, S, D = q.shape
        ks = shift_k.shape[-1]
        k_pad = _pad(k, ((0, 0), (ks - 1, 0), (0, 0)))
        k_shift = torch.zeros_like(k)
        for t in range(ks):
            k_shift = k_shift + k_pad[:, t:t + S, :] * shift_k[:, ks - 1 - t][None, None, :]
        kv = k_shift * v
        L = 2 * S
        kv_pad = _pad(kv, ((0, 0), (0, S), (0, 0)))
        kf_pad = _pad(ssm_k, ((0, 0), (0, S)))
        kv_f = (lambda x, axes=(-2,-1): torch.fft.rfft2(x.float(), dim=axes))(kv_pad[:, None, :, :], axes=(1, 2))
        kf_f = (lambda x, axes=(-2,-1): torch.fft.rfft2(x.float(), dim=axes))(kf_pad[:, None, :], axes=(1, 2))
        kf_f = (lambda x, *d: x.permute(*d))(kf_f, 1, 2, 0)
        y_f = kv_f * kf_f[None, :, :, :]
        y = (lambda x, s, axes=(-2,-1): torch.fft.irfft2(x, s=s, dim=axes).to(torch.bfloat16))(y_f, (1, L), axes=(1, 2))[:, 0, :S, :]
        y = y + kv * ssm_D[None, None, :]
        return q * y

    def _B_ref(x, W_gate, W_up, W_down):
        gate = torch.einsum("bsd,df->bsf", x, W_gate)
        up = torch.einsum("bsd,df->bsf", x, W_up)
        gate = gate * (lambda x, dt: x.to(dt))(gate > 0, gate.dtype)
        h = gate * up
        return torch.einsum("bsf,fd->bsd", h, W_down)

    x = A_q
    xn = _layernorm(x, axis=-1)
    return x + _A_ref(xn, A_k, A_v, A_shift_k, A_ssm_k, A_ssm_D) + _B_ref(xn, B_W_gate, B_W_up, B_W_down)
```

```asm
; @launch grid=(256,1,1) block=(256,1,1) lds=163840
.amdgcn_target "amdgcn-amd-amdhsa--gfx950"
.text
.globl parallel_sum__ssm_conv_h3__glu_gated_reglu__prompt_kernel
.p2align 8
.type parallel_sum__ssm_conv_h3__glu_gated_reglu__prompt_kernel,@function
parallel_sum__ssm_conv_h3__glu_gated_reglu__prompt_kernel:
    s_cmp_ge_u32 s2, 256
    s_cbranch_scc1 L_end
    s_load_dwordx16 s[48:63], s[0:1], 0
    s_load_dwordx8 s[64:71], s[0:1], 64
    s_load_dwordx2 s[72:73], s[0:1], 96
    s_cmp_lt_u32 s2, 32
    s_cbranch_scc1 L_helper
    s_sub_u32 s2, s2, 32
    s_getpc_b64 s[96:97]
L_pc:
    s_and_b32 s97, s97, 0xffff
    s_mov_b32 s98, L_code_end-L_pc
    s_mov_b32 s99, 0x20000
    v_lshlrev_b32 v4, 7, v0
    buffer_load_dword v95, v4, s[96:99], 0 offen
    v_lshrrev_b32 v4, 6, v0
    v_and_b32 v1, 63, v0
    v_readfirstlane_b32 s78, v4
    v_lshlrev_b32_e64 v2, 4, v1
    s_and_b32 s88, s2, 7
    s_lshr_b32 s89, s2, 3
    s_mul_i32 s86, s89, 37
    s_lshr_b32 s86, s86, 8
    s_mul_i32 s87, s86, 7
    s_sub_u32 s84, s89, s87
    s_lshl_b32 s83, s88, 2
    s_add_u32 s83, s83, s86
    s_lshr_b32 s87, s88, 1
    s_lshl_b32 s87, s87, 2
    s_add_u32 s81, s87, s86
    s_and_b32 s87, s88, 1
    s_mul_i32 s87, s87, 7
    s_add_u32 s82, s87, s84
    s_and_b32 s79, s78, 1
    s_lshr_b32 s80, s78, 1
    s_lshl_b32 s90, s78, 12
    s_mov_b32 s3, 0xffff0000
    v_lshrrev_b32 v4, 3, v1
    v_and_b32 v5, 7, v1
    v_lshrrev_b32 v6, 4, v1
    v_xor_b32 v7, v5, v6
    v_lshlrev_b32 v7, 4, v7
    s_lshl_b32 s86, s81, 7
    s_lshl_b32 s87, s78, 5
    s_add_u32 s86, s86, s87
    v_add_u32_e64 v8, s86, v4
    v_mul_u32_u24 v8, 896, v8
    v_add_u32_e64 v16, v8, v7
    v_add_u32 v18, 12288, v16
    v_xor_b32_e64 v17, 64, v16
    v_add_u32 v19, 18432, v17
    v_add_u32 v17, 6144, v17
    v_and_b32 v7, 1, v6
    v_lshlrev_b32 v7, 2, v7
    v_xor_b32 v7, v5, v7
    v_lshlrev_b32 v7, 4, v7
    s_lshl_b32 s86, s79, 5
    v_add_u32_e64 v8, s86, v4
    v_mul_u32_u24 v8, 3584, v8
    s_lshl_b32 s87, s82, 8
    v_add3_u32 v20, v8, v7, s87
    v_add_u32 v21, 27648, v20
    v_add_u32 v22, 55296, v20
    v_add_u32 v23, 82944, v20
    v_lshrrev_b32 v9, 3, v1
    v_and_b32 v10, 7, v1
    v_bfe_u32 v11, v1, 4, 1
    v_lshlrev_b32 v11, 2, v11
    v_xor_b32 v11, v10, v11
    v_lshlrev_b32 v11, 4, v11
    s_lshl_b32 s92, s80, 2
    s_add_u32 s92, s92, s79
    s_lshl_b32 s93, s92, 5
    v_add_u32_e64 v9, s93, v9
    v_mul_u32_u24 v9, 896, v9
    s_lshl_b32 s93, s84, 7
    v_add3_u32 v112, v9, v11, s93
    v_add_u32 v113, 6144, v112
    v_add_u32 v114, 12288, v112
    v_add_u32 v115, 18432, v112
    v_add_u32 v116, 57344, v112
    v_add_u32 v117, 57344, v113
    v_add_u32 v118, 57344, v114
    v_add_u32 v119, 57344, v115
    v_and_b32 v9, 3, v1
    v_bfe_u32 v10, v1, 2, 2
    v_bfe_u32 v11, v1, 4, 1
    v_lshrrev_b32 v12, 5, v1
    v_lshrrev_b32 v13, 1, v10
    v_lshlrev_b32_e64 v13, 6, v13
    v_lshl_add_u32 v13, v11, 5, v13
    v_lshl_add_u32 v13, v9, 3, v13
    v_lshl_add_u32 v13, v10, 7, v13
    v_lshl_add_u32 v13, v12, 9, v13
    s_add_u32 s93, s90, 49152
    v_add_u32 v120, s93, v13
    v_xor_b32 v121, 64, v120
    v_add_u32 v122, 65536, v120
    v_add_u32 v123, 65536, v121
    s_mul_i32 s93, s83, 112
    s_add_u32 s92, s92, s93
    s_lshl_b32 s92, s92, 11
    s_add_u32 s92, s92, 7340032
    v_add_u32_e64 v124, s92, v2
    v_add_u32 v125, 114688, v124
    v_add_u32 v126, 4096, v124
    v_add_u32 v127, 4096, v125
    s_lshr_b32 s86, s82, 1
    s_waitcnt lgkmcnt(0)
    s_mov_b32 s4, s48
    s_and_b32 s5, s49, 0xffff
    s_mov_b32 s6, 1835008
    s_mov_b32 s7, 0x20000
    s_cmp_eq_u32 s80, 0
    s_cselect_b32 s24, s62, s64
    s_cselect_b32 s25, s63, s65
    s_and_b32 s25, s25, 0xffff
    s_mov_b32 s26, 1605632
    s_mov_b32 s27, 0x20000
    s_mov_b32 s8, s50
    s_and_b32 s9, s51, 0xffff
    s_mov_b32 s10, 1835008
    s_mov_b32 s11, 0x20000
    s_mov_b32 s12, s52
    s_and_b32 s13, s53, 0xffff
    s_mov_b32 s14, 1835008
    s_mov_b32 s15, 0x20000
    s_mov_b32 s16, s54
    s_and_b32 s17, s55, 0xffff
    s_mov_b32 s18, 3584
    s_mov_b32 s19, 0x20000
    s_mov_b32 s20, s56
    s_and_b32 s21, s57, 0xffff
    s_mov_b32 s22, 1835008
    s_mov_b32 s23, 0x20000
    s_mov_b32 s44, s58
    s_and_b32 s45, s59, 0xffff
    s_mov_b32 s46, 896
    s_mov_b32 s47, 0x20000
    s_cmp_eq_u32 s79, 0
    s_cselect_b32 s96, s50, s54
    s_cselect_b32 s97, s51, s55
    s_mov_b32 s98, 3584
    s_cselect_b32 s98, 1835008, s98
    s_and_b32 s97, s97, 0xffff
    s_mov_b32 s99, 0x20000
    s_add_u32 s87, s86, 0
    s_cmp_ge_u32 s87, 7
    s_cselect_b32 s88, 7, 0
    s_sub_u32 s87, s87, s88
    s_lshl_b32 s48, s87, 7
    s_mul_i32 s55, s87, 229376
    s_add_u32 m0, s90, 0
    s_nop 0
    buffer_load_dwordx4 v16, s[4:7], s48 offen offset:0 lds
    s_mov_b32 s28, s66
    s_and_b32 s29, s67, 0xffff
    s_mov_b32 s30, 1605632
    buffer_load_dwordx4 v17, s[4:7], s48 offen offset:1024 lds
    s_mov_b32 s31, 0x20000
    s_mov_b32 s32, s68
    s_and_b32 s33, s69, 0xffff
    buffer_load_dwordx4 v18, s[4:7], s48 offen offset:2048 lds
    s_mov_b32 s34, 1835008
    s_mov_b32 s35, 0x20000
    s_mov_b32 s40, s70
    buffer_load_dwordx4 v19, s[4:7], s48 offen offset:3072 lds
    s_and_b32 s41, s71, 0xffff
    s_mov_b32 s42, 256
    s_mov_b32 s43, 0x20000
    s_add_u32 m0, s90, 65536
    s_nop 0
    buffer_load_dwordx4 v20, s[24:27], s55 offen offset:0 lds
    s_mov_b32 s36, s72
    s_and_b32 s37, s73, 0xffff
    s_mov_b32 s38, 16777216
    buffer_load_dwordx4 v21, s[24:27], s55 offen offset:1024 lds
    s_mov_b32 s39, 0x20000
    buffer_load_dwordx4 v22, s[24:27], s55 offen offset:2048 lds
    buffer_load_dwordx4 v23, s[24:27], s55 offen offset:3072 lds
    s_add_u32 s87, s86, 1
    s_cmp_ge_u32 s87, 7
    s_cselect_b32 s88, 7, 0
    s_sub_u32 s87, s87, s88
    s_lshl_b32 s49, s87, 7
    s_mul_i32 s56, s87, 229376
    s_add_u32 m0, s90, 16384
    s_nop 0
    buffer_load_dwordx4 v16, s[4:7], s49 offen offset:0 lds
    v_cmp_eq_u32 vcc, 0, v1
    v_mov_b32 v4, 0x7ffffff0
    s_nop 0
    v_cndmask_b32_e64 v3, v4, 0, vcc
    v_lshrrev_b32_e64 v4, 3, v1
    buffer_load_dwordx4 v17, s[4:7], s49 offen offset:1024 lds
    v_and_b32 v5, 7, v1
    s_lshl_b32 s87, s83, 6
    s_lshl_b32 s88, s78, 4
    s_add_u32 s88, s88, s87
    buffer_load_dwordx4 v18, s[4:7], s49 offen offset:2048 lds
    v_add_u32_e64 v6, s88, v4
    v_mul_u32_u24 v6, 896, v6
    s_lshl_b32 s88, s84, 7
    v_lshlrev_b32 v7, 4, v5
    buffer_load_dwordx4 v19, s[4:7], s49 offen offset:3072 lds
    v_add_u32_e64 v6, s88, v6
    s_lshl_b32 s89, s78, 1
    s_add_u32 s101, s89, 1
    s_and_b32 s101, s101, 7
    s_add_u32 m0, s90, 81920
    s_nop 0
    buffer_load_dwordx4 v20, s[24:27], s56 offen offset:0 lds
    v_xor_b32_e64 v8, s101, v5
    v_lshl_add_u32 v8, v8, 4, v6
    s_add_u32 s101, s89, 2
    s_and_b32 s101, s101, 7
    buffer_load_dwordx4 v21, s[24:27], s56 offen offset:1024 lds
    v_xor_b32_e64 v9, s101, v5
    v_lshl_add_u32 v9, v9, 4, v6
    v_add_u32 v9, 6144, v9
    s_add_u32 s101, s89, 0
    buffer_load_dwordx4 v22, s[24:27], s56 offen offset:2048 lds
    s_and_b32 s101, s101, 7
    v_xor_b32_e64 v13, s101, v5
    v_lshl_add_u32 v13, v13, 4, v6
    s_add_u32 s101, s89, 1
    buffer_load_dwordx4 v23, s[24:27], s56 offen offset:3072 lds
    s_and_b32 s101, s101, 7
    v_xor_b32_e64 v14, s101, v5
    v_lshl_add_u32 v14, v14, 4, v6
    v_add_u32 v14, 6144, v14
    s_sub_u32 s87, s87, 8
    v_add_u32 v6, s87, v4
    v_mul_i32_i24 v6, 896, v6
    v_add3_u32 v10, v6, v7, s88
    s_lshl_b32 s88, s84, 9
    v_add_u32 v11, s88, v2
    s_cmp_eq_u32 s79, 0
    s_cselect_b64 vcc, -1, 0
    v_cndmask_b32_e64 v10, v11, v10, vcc
    s_lshl_b32 s87, s78, 11
    s_add_u32 m0, s87, 132096
    s_nop 0
    buffer_load_dwordx4 v8, s[8:11], 0 offen lds
    buffer_load_dwordx4 v9, s[8:11], 0 offen offset:1024 lds
    s_add_u32 m0, s87, 141312
    s_nop 0
    buffer_load_dwordx4 v13, s[12:15], 0 offen lds
    buffer_load_dwordx4 v14, s[12:15], 0 offen offset:1024 lds
    s_mul_i32 s87, s79, 9216
    s_add_u32 m0, s87, 131072
    s_nop 0
    buffer_load_dwordx4 v10, s[96:99], 0 offen lds
    s_or_b32 s101, s2, s78
    s_cmp_lg_u32 s101, 0
    s_cbranch_scc1 L_nononce
    s_memrealtime s[94:95]
    s_waitcnt lgkmcnt(0)
    s_or_b32 s94, s94, 1
    v_mov_b32_e64 v12, s94
    buffer_store_dword v12, v3, s[40:43], 0 offen sc1
L_nononce:
    s_lshr_b32 s86, s82, 1
    s_add_u32 s87, s86, 2
    s_cmp_ge_u32 s87, 7
    s_cselect_b32 s88, 7, 0
    s_sub_u32 s87, s87, s88
    s_lshl_b32 s50, s87, 7
    s_mul_i32 s57, s87, 229376
    s_add_u32 s87, s86, 3
    s_cmp_ge_u32 s87, 7
    s_cselect_b32 s88, 7, 0
    s_sub_u32 s87, s87, s88
    s_lshl_b32 s51, s87, 7
    s_mul_i32 s58, s87, 229376
    s_add_u32 s87, s86, 4
    s_cmp_ge_u32 s87, 7
    s_cselect_b32 s88, 7, 0
    s_sub_u32 s87, s87, s88
    s_lshl_b32 s52, s87, 7
    s_mul_i32 s59, s87, 229376
    s_add_u32 s87, s86, 5
    s_cmp_ge_u32 s87, 7
    s_cselect_b32 s88, 7, 0
    s_sub_u32 s87, s87, s88
    s_lshl_b32 s53, s87, 7
    s_mul_i32 s60, s87, 229376
    s_add_u32 s87, s86, 6
    s_cmp_ge_u32 s87, 7
    s_cselect_b32 s88, 7, 0
    s_sub_u32 s87, s87, s88
    s_lshl_b32 s54, s87, 7
    s_mul_i32 s61, s87, 229376
    s_and_b32 s86, s82, 1
    s_lshl_b32 s86, s86, 1
    s_xor_b32 s86, s86, s79
    v_and_b32 v4, 31, v1
    v_lshrrev_b32 v5, 5, v1
    v_lshrrev_b32 v6, 1, v4
    v_and_b32 v6, 7, v6
    s_lshl_b32 s87, s86, 1
    v_or_b32 v7, s87, v5
    v_xor_b32 v7, v7, v6
    v_lshlrev_b32 v7, 4, v7
    v_lshl_add_u32 v7, v4, 7, v7
    s_lshl_b32 s87, s79, 13
    s_lshl_b32 s88, s80, 12
    s_add_u32 s87, s87, s88
    v_add_u32 v7, s87, v7
    v_xor_b32_e64 v24, 0, v7
    v_xor_b32 v25, 4096, v7
    v_xor_b32_e64 v26, 32, v7
    v_xor_b32 v27, 4128, v7
    v_xor_b32_e64 v28, 64, v7
    v_xor_b32 v29, 4160, v7
    v_xor_b32 v30, 96, v7
    v_xor_b32 v31, 4192, v7
    v_and_b32_e64 v4, 3, v1
    v_bfe_u32 v5, v1, 2, 2
    v_bfe_u32 v6, v1, 4, 1
    v_lshrrev_b32 v7, 5, v1
    v_lshrrev_b32 v8, 1, v5
    v_xor_b32 v8, s80, v8
    v_lshlrev_b32 v8, 6, v8
    v_lshl_add_u32 v8, v6, 5, v8
    v_lshl_add_u32 v8, v4, 3, v8
    v_lshl_add_u32 v8, v5, 7, v8
    v_lshl_add_u32 v8, v7, 10, v8
    s_lshl_b32 s87, s86, 11
    v_add_u32 v8, s87, v8
    v_xor_b32_e64 v32, 0, v8
    v_add_u32 v36, 65536, v32
    v_xor_b32 v33, 2048, v8
    v_add_u32 v37, 65536, v33
    v_xor_b32 v34, 4096, v8
    v_add_u32 v38, 65536, v34
    v_xor_b32 v35, 6144, v8
    v_add_u32 v39, 65536, v35
    v_and_b32_e64 v4, 15, v1
    v_bfe_u32 v5, v1, 4, 1
    v_cmp_eq_u32 vcc, v4, v5
    v_mov_b32 v6, 0x3f803f80
    s_nop 0
    v_cndmask_b32 v40, 0, v6, vcc
    v_cndmask_b32 v41, 0, v6, vcc
    v_cndmask_b32 v42, 0, v6, vcc
    v_cndmask_b32 v43, 0, v6, vcc
    v_mov_b32 v44, 0
    v_mov_b32 v45, 0
    v_mov_b32 v46, 0
    v_mov_b32 v47, 0
    v_mov_b32 v48, 0
    v_mov_b32 v49, 0
    v_mov_b32 v50, 0
    v_mov_b32 v51, 0
    v_mov_b32 v52, 0
    v_mov_b32 v53, 0
    v_mov_b32 v54, 0
    v_mov_b32_e64 v55, 0
    s_waitcnt vmcnt(13)
    s_barrier
    ds_read_b64_tr_b16 a[224:225], v36 offset:0
    ds_read_b64_tr_b16 a[226:227], v36 offset:512
    ds_read_b128 a[0:3], v24 offset:0
    ds_read_b128 a[4:7], v25 offset:0
    ds_read_b64_tr_b16 a[228:229], v36 offset:8192
    ds_read_b64_tr_b16 a[230:231], v36 offset:8704
    s_waitcnt lgkmcnt(0)
    v_mfma_f32_32x32x16_bf16 v[128:143], a[224:227], a[0:3], 0
    ds_read_b64_tr_b16 a[232:233], v37 offset:0
    ds_read_b64_tr_b16 a[234:235], v37 offset:512
    ds_read_b128 a[8:11], v26 offset:0
    s_add_u32 m0, s90, 32768
    s_nop 0
    buffer_load_dwordx4 v16, s[4:7], s50 offen offset:0 lds
    v_mfma_f32_32x32x16_bf16 v[144:159], a[224:227], a[4:7], 0
    ds_read_b128 a[12:15], v27 offset:0
    ds_read_b64_tr_b16 a[236:237], v37 offset:8192
    ds_read_b64_tr_b16 a[238:239], v37 offset:8704
    v_and_b32 v4, 7, v1
    v_lshrrev_b32_e64 v5, 3, v1
    v_mfma_f32_32x32x16_bf16 v[160:175], a[228:231], a[0:3], 0
    buffer_load_dwordx4 v17, s[4:7], s50 offen offset:1024 lds
    s_lshl_b32 s92, s78, 3
    v_add_u32 v5, s92, v5
    v_lshrrev_b32 v6, 2, v5
    v_and_b32 v7, 3, v5
    v_mfma_f32_32x32x16_bf16 v[176:191], a[228:231], a[4:7], 0
    v_lshlrev_b32_e64 v7, 2, v7
    v_lshl_add_u32 v7, v4, 10, v7
    v_xor_b32_e64 v8, v6, v4
    v_lshl_add_u32 v8, v8, 4, v7
    v_add_u32 v248, 131712, v8
    v_mfma_f32_16x16x32_bf16 v[44:47], v[40:43], a[0:3], v[44:47]
    buffer_load_dwordx4 v18, s[4:7], s50 offen offset:2048 lds
    v_mfma_f32_16x16x32_bf16 v[48:51], v[40:43], a[224:227], v[48:51]
    v_add_u32 v250, 141312, v8
    v_mfma_f32_16x16x32_bf16 v[52:55], v[40:43], a[228:231], v[52:55]
    s_waitcnt lgkmcnt(0)
    v_mfma_f32_32x32x16_bf16 v[128:143], a[232:235], a[8:11], v[128:143]
    ds_read_b64_tr_b16 a[240:241], v38 offset:0
    ds_read_b64_tr_b16 a[242:243], v38 offset:512
    ds_read_b128 a[16:19], v28 offset:0
    buffer_load_dwordx4 v19, s[4:7], s50 offen offset:3072 lds
    s_add_u32 m0, s90, 98304
    v_mfma_f32_32x32x16_bf16 v[144:159], a[232:235], a[12:15], v[144:159]
    ds_read_b128 a[20:23], v29 offset:0
    ds_read_b64_tr_b16 a[244:245], v38 offset:8192
    ds_read_b64_tr_b16 a[246:247], v38 offset:8704
    v_add_u32 v9, 1, v4
    v_and_b32_e64 v9, 7, v9
    v_mfma_f32_32x32x16_bf16 v[160:175], a[236:239], a[8:11], v[160:175]
    buffer_load_dwordx4 v20, s[24:27], s57 offen offset:0 lds
    v_xor_b32_e64 v9, v6, v9
    v_lshl_add_u32 v9, v9, 4, v7
    v_add_u32 v249, 132096, v9
    v_lshlrev_b32_e64 v9, 4, v5
    v_mfma_f32_32x32x16_bf16 v[176:191], a[236:239], a[12:15], v[176:191]
    v_add_u32 v251, 140288, v9
    v_lshlrev_b32 v9, 13, v5
    v_lshlrev_b32 v10, 4, v4
    v_sub_u32_e64 v252, v9, v10
    v_add_u32 v252, 4080, v252
    v_mfma_f32_16x16x32_bf16 v[44:47], v[40:43], a[8:11], v[44:47]
    s_waitcnt lgkmcnt(0)
    v_mfma_f32_32x32x16_bf16 v[128:143], a[240:243], a[16:19], v[128:143]
    ds_read_b64_tr_b16 a[224:225], v39 offset:0
    ds_read_b64_tr_b16 a[226:227], v39 offset:512
    ds_read_b128 a[24:27], v30 offset:0
    buffer_load_dwordx4 v21, s[24:27], s57 offen offset:1024 lds
    v_mfma_f32_32x32x16_bf16 v[144:159], a[240:243], a[20:23], v[144:159]
    ds_read_b128 a[28:31], v31 offset:0
    ds_read_b64_tr_b16 a[228:229], v39 offset:8192
    ds_read_b64_tr_b16 a[230:231], v39 offset:8704
    v_mfma_f32_32x32x16_bf16 v[160:175], a[244:247], a[16:19], v[160:175]
    buffer_load_dwordx4 v22, s[24:27], s57 offen offset:2048 lds
    v_mfma_f32_32x32x16_bf16 v[176:191], a[244:247], a[20:23], v[176:191]
    v_mfma_f32_16x16x32_bf16 v[44:47], v[40:43], a[16:19], v[44:47]
    buffer_load_dwordx4 v23, s[24:27], s57 offen offset:3072 lds
    v_mfma_f32_16x16x32_bf16 v[48:51], v[40:43], a[240:243], v[48:51]
    s_add_u32 m0, s90, 49152
    v_mfma_f32_16x16x32_bf16 v[52:55], v[40:43], a[244:247], v[52:55]
    s_waitcnt vmcnt(8) lgkmcnt(0)
    s_barrier
    v_mfma_f32_32x32x16_bf16 v[128:143], a[224:227], a[24:27], v[128:143]
    ds_read_b64_tr_b16 a[232:233], v36 offset:16384
    ds_read_b64_tr_b16 a[234:235], v36 offset:16896
    ds_read_b128 a[32:35], v24 offset:16384
    buffer_load_dwordx4 v16, s[4:7], s51 offen offset:0 lds
    ds_read_b128 v[212:215], v251
    v_mfma_f32_32x32x16_bf16 v[144:159], a[224:227], a[28:31], v[144:159]
    ds_read_b128 a[36:39], v25 offset:16384
    ds_read_b64_tr_b16 a[236:237], v36 offset:24576
    ds_read_b64_tr_b16 a[238:239], v36 offset:25088
    ds_read2_b32 v[192:193], v248 offset0:0 offset1:32
    ds_read_b32 v194, v248 offset:256
    v_mfma_f32_32x32x16_bf16 v[160:175], a[228:231], a[24:27], v[160:175]
    buffer_load_dwordx4 v17, s[4:7], s51 offen offset:1024 lds
    ds_read2_b32 v[196:197], v249 offset0:0 offset1:32
    ds_read2_b32 v[198:199], v249 offset0:64 offset1:96
    ds_read2_b32 v[200:201], v249 offset0:128 offset1:160
    ds_read2_b32 v[202:203], v249 offset0:192 offset1:224
    v_mfma_f32_32x32x16_bf16 v[176:191], a[228:231], a[28:31], v[176:191]
    ds_read2_b32 v[204:205], v250 offset0:0 offset1:32
    ds_read2_b32 v[206:207], v250 offset0:64 offset1:96
    ds_read2_b32 v[208:209], v250 offset0:128 offset1:160
    ds_read2_b32 v[210:211], v250 offset0:192 offset1:224
    v_accvgpr_read_b32 v96, a0
    v_mfma_f32_16x16x32_bf16 v[44:47], v[40:43], a[24:27], v[44:47]
    s_waitcnt lgkmcnt(10)
    v_mfma_f32_32x32x16_bf16 v[128:143], a[232:235], a[32:35], v[128:143]
    ds_read_b64_tr_b16 a[240:241], v37 offset:16384
    ds_read_b64_tr_b16 a[242:243], v37 offset:16896
    ds_read_b128 a[40:43], v26 offset:16384
    buffer_load_dwordx4 v18, s[4:7], s51 offen offset:2048 lds
    v_accvgpr_read_b32 v97, a1
    v_mfma_f32_32x32x16_bf16 v[144:159], a[232:235], a[36:39], v[144:159]
    ds_read_b128 a[44:47], v27 offset:16384
    ds_read_b64_tr_b16 a[244:245], v37 offset:24576
    ds_read_b64_tr_b16 a[246:247], v37 offset:25088
    v_accvgpr_read_b32 v98, a2
    v_accvgpr_read_b32 v99, a3
    v_mfma_f32_32x32x16_bf16 v[160:175], a[236:239], a[32:35], v[160:175]
    buffer_load_dwordx4 v19, s[4:7], s51 offen offset:3072 lds
    s_add_u32 m0, s90, 114688
    v_accvgpr_read_b32 v100, a8
    v_accvgpr_read_b32 v101, a9
    v_accvgpr_read_b32 v102, a10
    v_mfma_f32_32x32x16_bf16 v[176:191], a[236:239], a[36:39], v[176:191]
    s_waitcnt lgkmcnt(6)
    v_lshlrev_b32 v228, 16, v212
    v_and_b32 v229, s3, v212
    v_lshlrev_b32 v230, 16, v213
    v_and_b32_e64 v231, s3, v213
    v_mfma_f32_16x16x32_bf16 v[44:47], v[40:43], a[32:35], v[44:47]
    buffer_load_dwordx4 v20, s[24:27], s58 offen offset:0 lds
    v_mfma_f32_16x16x32_bf16 v[48:51], v[40:43], a[232:235], v[48:51]
    v_lshlrev_b32_e64 v216, 16, v192
    v_mfma_f32_16x16x32_bf16 v[52:55], v[40:43], a[236:239], v[52:55]
    s_waitcnt lgkmcnt(0)
    v_mfma_f32_32x32x16_bf16 v[128:143], a[240:243], a[40:43], v[128:143]
    ds_read_b64_tr_b16 a[224:225], v38 offset:16384
    ds_read_b64_tr_b16 a[226:227], v38 offset:16896
    ds_read_b128 a[48:51], v28 offset:16384
    buffer_load_dwordx4 v21, s[24:27], s58 offen offset:1024 lds
    v_lshlrev_b32 v217, 16, v193
    v_mfma_f32_32x32x16_bf16 v[144:159], a[240:243], a[44:47], v[144:159]
    ds_read_b128 a[52:55], v29 offset:16384
    ds_read_b64_tr_b16 a[228:229], v38 offset:24576
    ds_read_b64_tr_b16 a[230:231], v38 offset:25088
    v_lshlrev_b32 v218, 16, v194
    v_lshlrev_b32 v219, 16, v196
    v_mfma_f32_32x32x16_bf16 v[160:175], a[244:247], a[40:43], v[160:175]
    buffer_load_dwordx4 v22, s[24:27], s58 offen offset:2048 lds
    v_lshlrev_b32 v220, 16, v197
    v_lshlrev_b32 v221, 16, v198
    v_lshlrev_b32 v222, 16, v199
    v_lshlrev_b32 v223, 16, v200
    v_mfma_f32_32x32x16_bf16 v[176:191], a[244:247], a[44:47], v[176:191]
    v_lshlrev_b32 v224, 16, v201
    v_lshlrev_b32 v225, 16, v202
    v_lshlrev_b32 v226, 16, v203
    v_mul_f32 v232, v216, v231
    v_mul_f32_e64 v233, v217, v231
    v_mfma_f32_16x16x32_bf16 v[44:47], v[40:43], a[40:43], v[44:47]
    s_waitcnt lgkmcnt(0)
    v_mfma_f32_32x32x16_bf16 v[128:143], a[224:227], a[48:51], v[128:143]
    ds_read_b64_tr_b16 a[232:233], v39 offset:16384
    ds_read_b64_tr_b16 a[234:235], v39 offset:16896
    ds_read_b128 a[56:59], v30 offset:16384
    buffer_load_dwordx4 v23, s[24:27], s58 offen offset:3072 lds
    s_add_u32 m0, s90, 0
    v_mfma_f32_32x32x16_bf16 v[144:159], a[224:227], a[52:55], v[144:159]
    ds_read_b128 a[60:63], v31 offset:16384
    ds_read_b64_tr_b16 a[236:237], v39 offset:24576
    ds_read_b64_tr_b16 a[238:239], v39 offset:25088
    v_mul_f32 v234, v218, v231
    v_mul_f32 v235, v219, v231
    v_mfma_f32_32x32x16_bf16 v[160:175], a[228:231], a[48:51], v[160:175]
    buffer_load_dwordx4 v16, s[4:7], s52 offen offset:0 lds
    v_mul_f32 v236, v220, v231
    v_mul_f32 v237, v221, v231
    v_mul_f32 v238, v222, v231
    v_mul_f32 v239, v223, v231
    v_mfma_f32_32x32x16_bf16 v[176:191], a[228:231], a[52:55], v[176:191]
    v_fmac_f32 v232, v217, v230
    v_fmac_f32 v233, v218, v230
    v_fmac_f32 v234, v219, v230
    v_fmac_f32 v235, v220, v230
    v_fmac_f32_e64 v236, v221, v230
    v_mfma_f32_16x16x32_bf16 v[44:47], v[40:43], a[48:51], v[44:47]
    buffer_load_dwordx4 v17, s[4:7], s52 offen offset:1024 lds
    v_mfma_f32_16x16x32_bf16 v[48:51], v[40:43], a[224:227], v[48:51]
    v_fmac_f32_e64 v237, v222, v230
    v_mfma_f32_16x16x32_bf16 v[52:55], v[40:43], a[228:231], v[52:55]
    s_waitcnt vmcnt(10) lgkmcnt(0)
    s_barrier
    v_mfma_f32_32x32x16_bf16 v[128:143], a[232:235], a[56:59], v[128:143]
    ds_read_b64_tr_b16 a[240:241], v36 offset:32768
    ds_read_b64_tr_b16 a[242:243], v36 offset:33280
    ds_read_b128 a[64:67], v24 offset:32768
    buffer_load_dwordx4 v18, s[4:7], s52 offen offset:2048 lds
    v_fmac_f32_e64 v238, v223, v230
    v_mfma_f32_32x32x16_bf16 v[144:159], a[232:235], a[60:63], v[144:159]
    ds_read_b128 a[68:71], v25 offset:32768
    ds_read_b64_tr_b16 a[244:245], v36 offset:40960
    ds_read_b64_tr_b16 a[246:247], v36 offset:41472
    v_fmac_f32 v239, v224, v230
    v_fmac_f32 v232, v218, v229
    v_mfma_f32_32x32x16_bf16 v[160:175], a[236:239], a[56:59], v[160:175]
    buffer_load_dwordx4 v19, s[4:7], s52 offen offset:3072 lds
    s_add_u32 m0, s90, 65536
    v_fmac_f32 v233, v219, v229
    v_fmac_f32 v234, v220, v229
    v_fmac_f32_e64 v235, v221, v229
    v_mfma_f32_32x32x16_bf16 v[176:191], a[236:239], a[60:63], v[176:191]
    v_fmac_f32 v236, v222, v229
    v_fmac_f32 v237, v223, v229
    v_fmac_f32 v238, v224, v229
    v_fmac_f32 v239, v225, v229
    v_fmac_f32_e64 v232, v219, v228
    v_mfma_f32_16x16x32_bf16 v[44:47], v[40:43], a[56:59], v[44:47]
    s_waitcnt lgkmcnt(0)
    v_mfma_f32_32x32x16_bf16 v[128:143], a[240:243], a[64:67], v[128:143]
    ds_read_b64_tr_b16 a[224:225], v37 offset:32768
    ds_read_b64_tr_b16 a[226:227], v37 offset:33280
    ds_read_b128 a[72:75], v26 offset:32768
    buffer_load_dwordx4 v20, s[24:27], s59 offen offset:0 lds
    v_fmac_f32 v233, v220, v228
    v_mfma_f32_32x32x16_bf16 v[144:159], a[240:243], a[68:71], v[144:159]
    ds_read_b128 a[76:79], v27 offset:32768
    ds_read_b64_tr_b16 a[228:229], v37 offset:40960
    ds_read_b64_tr_b16 a[230:231], v37 offset:41472
    v_fmac_f32 v234, v221, v228
    v_fmac_f32 v235, v222, v228
    v_mfma_f32_32x32x16_bf16 v[160:175], a[244:247], a[64:67], v[160:175]
    buffer_load_dwordx4 v21, s[24:27], s59 offen offset:1024 lds
    v_fmac_f32 v236, v223, v228
    v_fmac_f32 v237, v224, v228
    v_fmac_f32 v238, v225, v228
    v_fmac_f32 v239, v226, v228
    v_mfma_f32_32x32x16_bf16 v[176:191], a[244:247], a[68:71], v[176:191]
    v_lshlrev_b32 v216, 16, v204
    v_lshlrev_b32 v217, 16, v205
    v_lshlrev_b32 v218, 16, v206
    v_lshlrev_b32 v219, 16, v207
    v_lshlrev_b32_e64 v220, 16, v208
    v_mfma_f32_16x16x32_bf16 v[44:47], v[40:43], a[64:67], v[44:47]
    buffer_load_dwordx4 v22, s[24:27], s59 offen offset:2048 lds
    v_mfma_f32_16x16x32_bf16 v[48:51], v[40:43], a[240:243], v[48:51]
    v_lshlrev_b32_e64 v221, 16, v209
    v_mfma_f32_16x16x32_bf16 v[52:55], v[40:43], a[244:247], v[52:55]
    s_waitcnt lgkmcnt(0)
    v_mfma_f32_32x32x16_bf16 v[128:143], a[224:227], a[72:75], v[128:143]
    ds_read_b64_tr_b16 a[232:233], v38 offset:32768
    ds_read_b64_tr_b16 a[234:235], v38 offset:33280
    ds_read_b128 a[80:83], v28 offset:32768
    buffer_load_dwordx4 v23, s[24:27], s59 offen offset:3072 lds
    s_add_u32 m0, s90, 16384
    v_mfma_f32_32x32x16_bf16 v[144:159], a[224:227], a[76:79], v[144:159]
    ds_read_b128 a[84:87], v29 offset:32768
    ds_read_b64_tr_b16 a[236:237], v38 offset:40960
    ds_read_b64_tr_b16 a[238:239], v38 offset:41472
    v_lshlrev_b32 v222, 16, v210
    v_lshlrev_b32_e64 v223, 16, v211
    v_mfma_f32_32x32x16_bf16 v[160:175], a[228:231], a[72:75], v[160:175]
    buffer_load_dwordx4 v16, s[4:7], s53 offen offset:0 lds
    v_mul_f32 v232, v232, v216
    v_mul_f32 v233, v233, v217
    v_mul_f32 v234, v234, v218
    v_mul_f32 v235, v235, v219
    v_mfma_f32_32x32x16_bf16 v[176:191], a[228:231], a[76:79], v[176:191]
    v_mul_f32 v236, v236, v220
    v_mul_f32 v237, v237, v221
    v_mul_f32 v238, v238, v222
    v_mul_f32_e64 v239, v239, v223
    v_cvt_pk_bf16_f32 v240, v239, v238
    v_mfma_f32_16x16x32_bf16 v[44:47], v[40:43], a[72:75], v[44:47]
    s_waitcnt lgkmcnt(0)
    v_mfma_f32_32x32x16_bf16 v[128:143], a[232:235], a[80:83], v[128:143]
    ds_read_b64_tr_b16 a[240:241], v39 offset:32768
    ds_read_b64_tr_b16 a[242:243], v39 offset:33280
    ds_read_b128 a[88:91], v30 offset:32768
    buffer_load_dwordx4 v17, s[4:7], s53 offen offset:1024 lds
    v_cvt_pk_bf16_f32 v241, v237, v236
    v_mfma_f32_32x32x16_bf16 v[144:159], a[232:235], a[84:87], v[144:159]
    ds_read_b128 a[92:95], v31 offset:32768
    ds_read_b64_tr_b16 a[244:245], v39 offset:40960
    ds_read_b64_tr_b16 a[246:247], v39 offset:41472
    v_cvt_pk_bf16_f32 v242, v235, v234
    v_cvt_pk_bf16_f32 v243, v233, v232
    v_mfma_f32_32x32x16_bf16 v[160:175], a[236:239], a[80:83], v[160:175]
    buffer_load_dwordx4 v18, s[4:7], s53 offen offset:2048 lds
    v_lshlrev_b32 v228, 16, v214
    v_and_b32 v229, s3, v214
    v_lshlrev_b32 v230, 16, v215
    v_and_b32 v231, s3, v215
    v_mfma_f32_32x32x16_bf16 v[176:191], a[236:239], a[84:87], v[176:191]
    v_and_b32 v216, s3, v192
    v_and_b32 v217, s3, v193
    v_and_b32 v218, s3, v194
    v_and_b32 v219, s3, v196
    v_and_b32_e64 v220, s3, v197
    v_mfma_f32_16x16x32_bf16 v[44:47], v[40:43], a[80:83], v[44:47]
    buffer_load_dwordx4 v19, s[4:7], s53 offen offset:3072 lds
    v_mfma_f32_16x16x32_bf16 v[48:51], v[40:43], a[232:235], v[48:51]
    s_add_u32 m0, s90, 81920
    v_mfma_f32_16x16x32_bf16 v[52:55], v[40:43], a[236:239], v[52:55]
    s_waitcnt vmcnt(12) lgkmcnt(0)
    s_barrier
    v_mfma_f32_32x32x16_bf16 v[128:143], a[240:243], a[88:91], v[128:143]
    ds_read_b64_tr_b16 a[224:225], v36 offset:49152
    ds_read_b64_tr_b16 a[226:227], v36 offset:49664
    ds_read_b128 a[96:99], v24 offset:49152
    buffer_load_dwordx4 v20, s[24:27], s60 offen offset:0 lds
    v_and_b32_e64 v221, s3, v198
    v_mfma_f32_32x32x16_bf16 v[144:159], a[240:243], a[92:95], v[144:159]
    ds_read_b128 a[100:103], v25 offset:49152
    ds_read_b64_tr_b16 a[228:229], v36 offset:57344
    ds_read_b64_tr_b16 a[230:231], v36 offset:57856
    v_and_b32 v222, s3, v199
    v_and_b32 v223, s3, v200
    v_mfma_f32_32x32x16_bf16 v[160:175], a[244:247], a[88:91], v[160:175]
    buffer_load_dwordx4 v21, s[24:27], s60 offen offset:1024 lds
    v_and_b32 v224, s3, v201
    v_and_b32 v225, s3, v202
    v_and_b32 v226, s3, v203
    v_mul_f32 v232, v216, v231
    v_mfma_f32_32x32x16_bf16 v[176:191], a[244:247], a[92:95], v[176:191]
    v_mul_f32 v233, v217, v231
    v_mul_f32 v234, v218, v231
    v_mul_f32 v235, v219, v231
    v_mul_f32 v236, v220, v231
    v_mul_f32_e64 v237, v221, v231
    v_mfma_f32_16x16x32_bf16 v[44:47], v[40:43], a[88:91], v[44:47]
    s_waitcnt lgkmcnt(0)
    v_mfma_f32_32x32x16_bf16 v[128:143], a[224:227], a[96:99], v[128:143]
    ds_read_b64_tr_b16 a[232:233], v37 offset:49152
    ds_read_b64_tr_b16 a[234:235], v37 offset:49664
    ds_read_b128 a[104:107], v26 offset:49152
    buffer_load_dwordx4 v22, s[24:27], s60 offen offset:2048 lds
    v_mul_f32 v238, v222, v231
    v_mfma_f32_32x32x16_bf16 v[144:159], a[224:227], a[100:103], v[144:159]
    ds_read_b128 a[108:111], v27 offset:49152
    ds_read_b64_tr_b16 a[236:237], v37 offset:57344
    ds_read_b64_tr_b16 a[238:239], v37 offset:57856
    v_mul_f32 v239, v223, v231
    v_fmac_f32 v232, v217, v230
    v_mfma_f32_32x32x16_bf16 v[160:175], a[228:231], a[96:99], v[160:175]
    buffer_load_dwordx4 v23, s[24:27], s60 offen offset:3072 lds
    s_add_u32 m0, s90, 32768
    v_fmac_f32 v233, v218, v230
    v_fmac_f32 v234, v219, v230
    v_fmac_f32_e64 v235, v220, v230
    v_mfma_f32_32x32x16_bf16 v[176:191], a[228:231], a[100:103], v[176:191]
    v_fmac_f32 v236, v221, v230
    v_fmac_f32 v237, v222, v230
    v_fmac_f32 v238, v223, v230
    v_fmac_f32 v239, v224, v230
    v_fmac_f32_e64 v232, v218, v229
    v_mfma_f32_16x16x32_bf16 v[44:47], v[40:43], a[96:99], v[44:47]
    buffer_load_dwordx4 v16, s[4:7], s54 offen offset:0 lds
    v_mfma_f32_16x16x32_bf16 v[48:51], v[40:43], a[224:227], v[48:51]
    v_fmac_f32_e64 v233, v219, v229
    v_mfma_f32_16x16x32_bf16 v[52:55], v[40:43], a[228:231], v[52:55]
    s_waitcnt lgkmcnt(0)
    v_mfma_f32_32x32x16_bf16 v[128:143], a[232:235], a[104:107], v[128:143]
    ds_read_b64_tr_b16 a[240:241], v38 offset:49152
    ds_read_b64_tr_b16 a[242:243], v38 offset:49664
    ds_read_b128 a[112:115], v28 offset:49152
    buffer_load_dwordx4 v17, s[4:7], s54 offen offset:1024 lds
    v_fmac_f32 v234, v220, v229
    v_mfma_f32_32x32x16_bf16 v[144:159], a[232:235], a[108:111], v[144:159]
    ds_read_b128 a[116:119], v29 offset:49152
    ds_read_b64_tr_b16 a[244:245], v38 offset:57344
    ds_read_b64_tr_b16 a[246:247], v38 offset:57856
    v_fmac_f32 v235, v221, v229
    v_fmac_f32 v236, v222, v229
    v_mfma_f32_32x32x16_bf16 v[160:175], a[236:239], a[104:107], v[160:175]
    buffer_load_dwordx4 v18, s[4:7], s54 offen offset:2048 lds
    v_fmac_f32 v237, v223, v229
    v_fmac_f32 v238, v224, v229
    v_fmac_f32 v239, v225, v229
    v_fmac_f32 v232, v219, v228
    v_mfma_f32_32x32x16_bf16 v[176:191], a[236:239], a[108:111], v[176:191]
    v_fmac_f32 v233, v220, v228
    v_fmac_f32 v234, v221, v228
    v_fmac_f32 v235, v222, v228
    v_fmac_f32 v236, v223, v228
    v_fmac_f32_e64 v237, v224, v228
    v_mfma_f32_16x16x32_bf16 v[44:47], v[40:43], a[104:107], v[44:47]
    s_waitcnt lgkmcnt(0)
    v_mfma_f32_32x32x16_bf16 v[128:143], a[240:243], a[112:115], v[128:143]
    ds_read_b64_tr_b16 a[224:225], v39 offset:49152
    ds_read_b64_tr_b16 a[226:227], v39 offset:49664
    ds_read_b128 a[120:123], v30 offset:49152
    buffer_load_dwordx4 v19, s[4:7], s54 offen offset:3072 lds
    s_add_u32 m0, s90, 98304
    v_mfma_f32_32x32x16_bf16 v[144:159], a[240:243], a[116:119], v[144:159]
    ds_read_b128 a[124:127], v31 offset:49152
    ds_read_b64_tr_b16 a[228:229], v39 offset:57344
    ds_read_b64_tr_b16 a[230:231], v39 offset:57856
    v_fmac_f32 v238, v225, v228
    v_fmac_f32_e64 v239, v226, v228
    v_mfma_f32_32x32x16_bf16 v[160:175], a[244:247], a[112:115], v[160:175]
    buffer_load_dwordx4 v20, s[24:27], s61 offen offset:0 lds
    v_and_b32 v216, s3, v204
    v_and_b32 v217, s3, v205
    v_and_b32 v218, s3, v206
    v_and_b32 v219, s3, v207
    v_mfma_f32_32x32x16_bf16 v[176:191], a[244:247], a[116:119], v[176:191]
    v_and_b32 v220, s3, v208
    v_and_b32 v221, s3, v209
    v_and_b32 v222, s3, v210
    v_and_b32 v223, s3, v211
    v_mul_f32_e64 v232, v232, v216
    v_mfma_f32_16x16x32_bf16 v[44:47], v[40:43], a[112:115], v[44:47]
    buffer_load_dwordx4 v21, s[24:27], s61 offen offset:1024 lds
    v_mfma_f32_16x16x32_bf16 v[48:51], v[40:43], a[240:243], v[48:51]
    v_mul_f32_e64 v233, v233, v217
    v_mfma_f32_16x16x32_bf16 v[52:55], v[40:43], a[244:247], v[52:55]
    s_waitcnt vmcnt(14) lgkmcnt(0)
    s_barrier
    v_mfma_f32_32x32x16_bf16 v[128:143], a[224:227], a[120:123], v[128:143]
    ds_read_b64_tr_b16 a[232:233], v36 offset:0
    ds_read_b64_tr_b16 a[234:235], v36 offset:512
    ds_read_b128 a[128:131], v24 offset:0
    buffer_load_dwordx4 v22, s[24:27], s61 offen offset:2048 lds
    v_mul_f32_e64 v234, v234, v218
    v_mfma_f32_32x32x16_bf16 v[144:159], a[224:227], a[124:127], v[144:159]
    ds_read_b128 a[132:135], v25 offset:0
    ds_read_b64_tr_b16 a[236:237], v36 offset:8192
    ds_read_b64_tr_b16 a[238:239], v36 offset:8704
    v_mul_f32 v235, v235, v219
    v_mul_f32 v236, v236, v220
    v_mfma_f32_32x32x16_bf16 v[160:175], a[228:231], a[120:123], v[160:175]
    buffer_load_dwordx4 v23, s[24:27], s61 offen offset:3072 lds
    s_add_u32 m0, s90, 114688
    s_add_u32 s91, s55, 128
    v_mul_f32 v237, v237, v221
    v_mul_f32 v238, v238, v222
    v_mfma_f32_32x32x16_bf16 v[176:191], a[228:231], a[124:127], v[176:191]
    v_mul_f32_e64 v239, v239, v223
    v_cvt_pk_bf16_f32 v244, v239, v238
    v_cvt_pk_bf16_f32 v245, v237, v236
    v_cvt_pk_bf16_f32 v246, v235, v234
    v_cvt_pk_bf16_f32 v247, v233, v232
    v_mfma_f32_16x16x32_bf16 v[44:47], v[40:43], a[120:123], v[44:47]
    s_waitcnt lgkmcnt(0)
    v_mfma_f32_32x32x16_bf16 v[128:143], a[232:235], a[128:131], v[128:143]
    ds_read_b64_tr_b16 a[240:241], v37 offset:0
    ds_read_b64_tr_b16 a[242:243], v37 offset:512
    ds_read_b128 a[136:139], v26 offset:0
    buffer_load_dwordx4 v20, s[24:27], s91 offen offset:0 lds
    s_lshl_b32 s92, s84, 18
    v_mfma_f32_32x32x16_bf16 v[144:159], a[232:235], a[132:135], v[144:159]
    ds_read_b128 a[140:143], v27 offset:0
    ds_read_b64_tr_b16 a[244:245], v37 offset:8192
    ds_read_b64_tr_b16 a[246:247], v37 offset:8704
    s_lshl_b32 s93, s83, 7
    s_sub_u32 s92, s92, s93
    v_mfma_f32_32x32x16_bf16 v[160:175], a[236:239], a[128:131], v[160:175]
    buffer_load_dwordx4 v21, s[24:27], s91 offen offset:1024 lds
    s_add_u32 s92, s92, 1048576
    s_add_u32 s93, s92, 4096
    v_accvgpr_read_b32 v103, a11
    v_lshlrev_b32_e64 v106, 16, v96
    v_mfma_f32_32x32x16_bf16 v[176:191], a[236:239], a[132:135], v[176:191]
    v_and_b32 v107, s3, v96
    v_add_f32 v104, v106, v107
    v_mul_f32 v105, v106, v106
    v_fmac_f32 v105, v107, v107
    v_lshlrev_b32_e64 v106, 16, v97
    v_mfma_f32_16x16x32_bf16 v[44:47], v[40:43], a[128:131], v[44:47]
    buffer_store_dwordx4 v[240:243], v252, s[36:39], s92 offen sc1
    v_mfma_f32_16x16x32_bf16 v[48:51], v[40:43], a[232:235], v[48:51]
    v_and_b32_e64 v107, s3, v97
    v_mfma_f32_16x16x32_bf16 v[52:55], v[40:43], a[236:239], v[52:55]
    s_waitcnt lgkmcnt(0)
    v_mfma_f32_32x32x16_bf16 v[128:143], a[240:243], a[136:139], v[128:143]
    ds_read_b64_tr_b16 a[224:225], v38 offset:0
    ds_read_b64_tr_b16 a[226:227], v38 offset:512
    ds_read_b128 a[144:147], v28 offset:0
    buffer_store_dwordx4 v[244:247], v252, s[36:39], s93 offen sc1
    v_add_f32 v104, v104, v106
    v_mfma_f32_32x32x16_bf16 v[144:159], a[240:243], a[140:143], v[144:159]
    ds_read_b128 a[148:151], v29 offset:0
    ds_read_b64_tr_b16 a[228:229], v38 offset:8192
    ds_read_b64_tr_b16 a[230:231], v38 offset:8704
    v_fmac_f32 v105, v106, v106
    v_add_f32 v104, v104, v107
    v_mfma_f32_32x32x16_bf16 v[160:175], a[244:247], a[136:139], v[160:175]
    buffer_load_dwordx4 v22, s[24:27], s91 offen offset:2048 lds
    v_fmac_f32 v105, v107, v107
    v_lshlrev_b32 v106, 16, v98
    v_and_b32 v107, s3, v98
    v_add_f32 v104, v104, v106
    v_mfma_f32_32x32x16_bf16 v[176:191], a[244:247], a[140:143], v[176:191]
    v_fmac_f32 v105, v106, v106
    v_add_f32 v104, v104, v107
    v_fmac_f32 v105, v107, v107
    v_lshlrev_b32 v106, 16, v99
    v_and_b32_e64 v107, s3, v99
    v_mfma_f32_16x16x32_bf16 v[44:47], v[40:43], a[136:139], v[44:47]
    s_waitcnt lgkmcnt(0)
    v_mfma_f32_32x32x16_bf16 v[128:143], a[224:227], a[144:147], v[128:143]
    ds_read_b64_tr_b16 a[232:233], v39 offset:0
    ds_read_b64_tr_b16 a[234:235], v39 offset:512
    ds_read_b128 a[152:155], v30 offset:0
    buffer_load_dwordx4 v23, s[24:27], s91 offen offset:3072 lds
    s_add_u32 m0, s90, 49152
    v_mfma_f32_32x32x16_bf16 v[144:159], a[224:227], a[148:151], v[144:159]
    ds_read_b128 a[156:159], v31 offset:0
    ds_read_b64_tr_b16 a[236:237], v39 offset:8192
    ds_read_b64_tr_b16 a[238:239], v39 offset:8704
    s_add_u32 s91, s56, 128
    v_add_f32 v104, v104, v106
    v_mfma_f32_32x32x16_bf16 v[160:175], a[228:231], a[144:147], v[160:175]
    buffer_load_dwordx4 v20, s[24:27], s91 offen offset:0 lds
    v_fmac_f32 v105, v106, v106
    v_add_f32 v104, v104, v107
    v_fmac_f32 v105, v107, v107
    v_lshlrev_b32 v106, 16, v100
    v_mfma_f32_32x32x16_bf16 v[176:191], a[228:231], a[148:151], v[176:191]
    v_and_b32 v107, s3, v100
    v_add_f32 v104, v104, v106
    v_fmac_f32 v105, v106, v106
    v_add_f32 v104, v104, v107
    v_fmac_f32_e64 v105, v107, v107
    v_mfma_f32_16x16x32_bf16 v[44:47], v[40:43], a[144:147], v[44:47]
    buffer_load_dwordx4 v21, s[24:27], s91 offen offset:1024 lds
    v_mfma_f32_16x16x32_bf16 v[48:51], v[40:43], a[224:227], v[48:51]
    v_lshlrev_b32_e64 v106, 16, v101
    v_mfma_f32_16x16x32_bf16 v[52:55], v[40:43], a[228:231], v[52:55]
    s_waitcnt vmcnt(16) lgkmcnt(0)
    s_barrier
    v_mfma_f32_32x32x16_bf16 v[128:143], a[232:235], a[152:155], v[128:143]
    ds_read_b64_tr_b16 a[240:241], v36 offset:16384
    ds_read_b64_tr_b16 a[242:243], v36 offset:16896
    ds_read_b128 a[160:163], v24 offset:16384
    buffer_load_dwordx4 v22, s[24:27], s91 offen offset:2048 lds
    v_and_b32_e64 v107, s3, v101
    v_mfma_f32_32x32x16_bf16 v[144:159], a[232:235], a[156:159], v[144:159]
    ds_read_b128 a[164:167], v25 offset:16384
    ds_read_b64_tr_b16 a[244:245], v36 offset:24576
    ds_read_b64_tr_b16 a[246:247], v36 offset:25088
    v_add_f32 v104, v104, v106
    v_fmac_f32 v105, v106, v106
    v_mfma_f32_32x32x16_bf16 v[160:175], a[236:239], a[152:155], v[160:175]
    buffer_load_dwordx4 v23, s[24:27], s91 offen offset:3072 lds
    s_add_u32 m0, s90, 65536
    s_add_u32 s91, s57, 128
    v_add_f32 v104, v104, v107
    v_fmac_f32 v105, v107, v107
    v_mfma_f32_32x32x16_bf16 v[176:191], a[236:239], a[156:159], v[176:191]
    v_lshlrev_b32 v106, 16, v102
    v_and_b32 v107, s3, v102
    v_add_f32 v104, v104, v106
    v_fmac_f32 v105, v106, v106
    v_add_f32_e64 v104, v104, v107
    v_mfma_f32_16x16x32_bf16 v[44:47], v[40:43], a[152:155], v[44:47]
    s_waitcnt lgkmcnt(0)
    v_mfma_f32_32x32x16_bf16 v[128:143], a[240:243], a[160:163], v[128:143]
    ds_read_b64_tr_b16 a[224:225], v37 offset:16384
    ds_read_b64_tr_b16 a[226:227], v37 offset:16896
    ds_read_b128 a[168:171], v26 offset:16384
    buffer_load_dwordx4 v20, s[24:27], s91 offen offset:0 lds
    v_fmac_f32 v105, v107, v107
    v_mfma_f32_32x32x16_bf16 v[144:159], a[240:243], a[164:167], v[144:159]
    ds_read_b128 a[172:175], v27 offset:16384
    ds_read_b64_tr_b16 a[228:229], v37 offset:24576
    ds_read_b64_tr_b16 a[230:231], v37 offset:25088
    v_lshlrev_b32 v106, 16, v103
    v_and_b32 v107, s3, v103
    v_mfma_f32_32x32x16_bf16 v[160:175], a[244:247], a[160:163], v[160:175]
    buffer_load_dwordx4 v21, s[24:27], s91 offen offset:1024 lds
    v_add_f32 v104, v104, v106
    v_fmac_f32 v105, v106, v106
    v_add_f32 v104, v104, v107
    v_fmac_f32 v105, v107, v107
    v_mfma_f32_32x32x16_bf16 v[176:191], a[244:247], a[164:167], v[176:191]
    v_lshrrev_b32 v106, 5, v1
    v_lshlrev_b32 v106, 9, v106
    v_and_b32 v107, 31, v1
    v_permlane32_swap_b32 v104, v105
    v_lshl_add_u32 v106, v107, 2, v106
    v_mfma_f32_16x16x32_bf16 v[44:47], v[40:43], a[160:163], v[44:47]
    buffer_load_dwordx4 v22, s[24:27], s91 offen offset:2048 lds
    v_mfma_f32_16x16x32_bf16 v[48:51], v[40:43], a[240:243], v[48:51]
    v_add_f32_e64 v104, v104, v105
    v_mfma_f32_16x16x32_bf16 v[52:55], v[40:43], a[244:247], v[52:55]
    s_waitcnt lgkmcnt(0)
    v_mfma_f32_32x32x16_bf16 v[128:143], a[224:227], a[168:171], v[128:143]
    ds_read_b64_tr_b16 a[232:233], v38 offset:16384
    ds_read_b64_tr_b16 a[234:235], v38 offset:16896
    ds_read_b128 a[176:179], v28 offset:16384
    buffer_load_dwordx4 v23, s[24:27], s91 offen offset:3072 lds
    s_add_u32 m0, s90, 0
    v_mfma_f32_32x32x16_bf16 v[144:159], a[224:227], a[172:175], v[144:159]
    ds_read_b128 a[180:183], v29 offset:16384
    ds_read_b64_tr_b16 a[236:237], v38 offset:24576
    ds_read_b64_tr_b16 a[238:239], v38 offset:25088
    s_add_u32 s91, s58, 128
    s_mul_i32 s96, s81, 14
    v_mfma_f32_32x32x16_bf16 v[160:175], a[228:231], a[168:171], v[160:175]
    buffer_load_dwordx4 v20, s[24:27], s91 offen offset:0 lds
    s_add_u32 s96, s96, s82
    s_lshl_b32 s96, s96, 10
    s_lshl_b32 s97, s79, 8
    s_add_u32 s96, s96, s97
    v_mfma_f32_32x32x16_bf16 v[176:191], a[228:231], a[172:175], v[176:191]
    s_lshl_b32 s97, s80, 7
    s_add_u32 s96, s96, s97
    s_add_u32 s96, s96, 2883584
    v_mfma_f32_16x16x32_bf16 v[44:47], v[40:43], a[168:171], v[44:47]
    s_waitcnt lgkmcnt(0)
    v_mfma_f32_32x32x16_bf16 v[128:143], a[232:235], a[176:179], v[128:143]
    ds_read_b64_tr_b16 a[240:241], v39 offset:16384
    ds_read_b64_tr_b16 a[242:243], v39 offset:16896
    ds_read_b128 a[184:187], v30 offset:16384
    buffer_store_dword v104, v106, s[36:39], s96 offen sc1
    buffer_load_dwordx4 v21, s[24:27], s91 offen offset:1024 lds
    v_mfma_f32_32x32x16_bf16 v[144:159], a[232:235], a[180:183], v[144:159]
    ds_read_b128 a[188:191], v31 offset:16384
    ds_read_b64_tr_b16 a[244:245], v39 offset:24576
    ds_read_b64_tr_b16 a[246:247], v39 offset:25088
    v_mov_b32_e64 v107, 0
    v_mfma_f32_32x32x16_bf16 v[160:175], a[236:239], a[176:179], v[160:175]
    buffer_load_dword v90, v107, s[40:43], 0 offen sc1
    s_lshl_b32 s86, s81, 2
    s_lshl_b32 s87, s79, 1
    s_add_u32 s86, s86, s87
    s_add_u32 s87, s86, s80
    v_mfma_f32_32x32x16_bf16 v[176:191], a[236:239], a[180:183], v[176:191]
    buffer_load_dwordx4 v22, s[24:27], s91 offen offset:2048 lds
    s_xor_b32 s88, s87, 1
    s_lshl_b32 s89, s82, 2
    s_add_u32 s89, s89, s80
    s_mul_i32 s62, s87, 56
    v_mfma_f32_16x16x32_bf16 v[44:47], v[40:43], a[176:179], v[44:47]
    s_add_u32 s62, s62, s89
    v_mfma_f32_16x16x32_bf16 v[48:51], v[40:43], a[232:235], v[48:51]
    s_lshl_b32 s62, s62, 11
    v_mfma_f32_16x16x32_bf16 v[52:55], v[40:43], a[236:239], v[52:55]
    s_waitcnt vmcnt(19) lgkmcnt(0)
    s_barrier
    v_mfma_f32_32x32x16_bf16 v[128:143], a[240:243], a[184:187], v[128:143]
    ds_read_b64_tr_b16 a[224:225], v36 offset:32768
    ds_read_b64_tr_b16 a[226:227], v36 offset:33280
    ds_read_b128 a[192:195], v24 offset:32768
    buffer_load_dwordx4 v23, s[24:27], s91 offen offset:3072 lds
    s_add_u32 m0, s90, 81920
    v_mfma_f32_32x32x16_bf16 v[144:159], a[240:243], a[188:191], v[144:159]
    ds_read_b128 a[196:199], v25 offset:32768
    ds_read_b64_tr_b16 a[228:229], v36 offset:40960
    ds_read_b64_tr_b16 a[230:231], v36 offset:41472
    s_add_u32 s91, s59, 128
    s_add_u32 s62, s62, 7340032
    v_mfma_f32_32x32x16_bf16 v[160:175], a[244:247], a[184:187], v[160:175]
    buffer_load_dwordx4 v20, s[24:27], s91 offen offset:0 lds
    s_mul_i32 s63, s88, 56
    s_add_u32 s63, s63, s89
    s_lshl_b32 s63, s63, 11
    s_add_u32 s63, s63, 7340032
    v_mfma_f32_32x32x16_bf16 v[176:191], a[244:247], a[188:191], v[176:191]
    s_mov_b32 s65, 16384
    s_mov_b32 s72, 229376
    s_mov_b32 s66, 32768
    s_mov_b32 s73, 458752
    s_mov_b32 s67, 49152
    v_mfma_f32_16x16x32_bf16 v[44:47], v[40:43], a[184:187], v[44:47]
    s_waitcnt lgkmcnt(0)
    v_mfma_f32_32x32x16_bf16 v[128:143], a[224:227], a[192:195], v[128:143]
    ds_read_b64_tr_b16 a[232:233], v37 offset:32768
    ds_read_b64_tr_b16 a[234:235], v37 offset:33280
    ds_read_b128 a[200:203], v26 offset:32768
    buffer_load_dwordx4 v21, s[24:27], s91 offen offset:1024 lds
    s_mov_b32 s74, 688128
    v_mfma_f32_32x32x16_bf16 v[144:159], a[224:227], a[196:199], v[144:159]
    ds_read_b128 a[204:207], v27 offset:32768
    ds_read_b64_tr_b16 a[236:237], v37 offset:40960
    ds_read_b64_tr_b16 a[238:239], v37 offset:41472
    s_mov_b32 s68, 65536
    s_mov_b32 s75, 917504
    v_mfma_f32_32x32x16_bf16 v[160:175], a[228:231], a[192:195], v[160:175]
    buffer_load_dwordx4 v22, s[24:27], s91 offen offset:2048 lds
    s_mov_b32 s69, 81920
    s_mov_b32 s76, 1146880
    s_mov_b32 s70, 98304
    s_mov_b32 s77, 1376256
    v_mfma_f32_32x32x16_bf16 v[176:191], a[228:231], a[196:199], v[176:191]
    v_mfma_f32_16x16x32_bf16 v[44:47], v[40:43], a[192:195], v[44:47]
    buffer_load_dwordx4 v23, s[24:27], s91 offen offset:3072 lds
    v_mfma_f32_16x16x32_bf16 v[48:51], v[40:43], a[224:227], v[48:51]
    s_add_u32 m0, s90, 16384
    v_mfma_f32_16x16x32_bf16 v[52:55], v[40:43], a[228:231], v[52:55]
    s_waitcnt lgkmcnt(0)
    v_mfma_f32_32x32x16_bf16 v[128:143], a[232:235], a[200:203], v[128:143]
    ds_read_b64_tr_b16 a[240:241], v38 offset:32768
    ds_read_b64_tr_b16 a[242:243], v38 offset:33280
    ds_read_b128 a[208:211], v28 offset:32768
    s_add_u32 s91, s60, 128
    buffer_load_dwordx4 v20, s[24:27], s91 offen offset:0 lds
    v_mfma_f32_32x32x16_bf16 v[144:159], a[232:235], a[204:207], v[144:159]
    ds_read_b128 a[212:215], v29 offset:32768
    ds_read_b64_tr_b16 a[244:245], v38 offset:40960
    ds_read_b64_tr_b16 a[246:247], v38 offset:41472
    v_mfma_f32_32x32x16_bf16 v[160:175], a[236:239], a[200:203], v[160:175]
    buffer_load_dwordx4 v21, s[24:27], s91 offen offset:1024 lds
    v_mfma_f32_32x32x16_bf16 v[176:191], a[236:239], a[204:207], v[176:191]
    v_mfma_f32_16x16x32_bf16 v[44:47], v[40:43], a[200:203], v[44:47]
    s_waitcnt lgkmcnt(0)
    v_mfma_f32_32x32x16_bf16 v[128:143], a[240:243], a[208:211], v[128:143]
    ds_read_b64_tr_b16 a[224:225], v39 offset:32768
    ds_read_b64_tr_b16 a[226:227], v39 offset:33280
    ds_read_b128 a[216:219], v30 offset:32768
    buffer_load_dwordx4 v22, s[24:27], s91 offen offset:2048 lds
    v_mfma_f32_32x32x16_bf16 v[144:159], a[240:243], a[212:215], v[144:159]
    ds_read_b128 a[220:223], v31 offset:32768
    ds_read_b64_tr_b16 a[228:229], v39 offset:40960
    ds_read_b64_tr_b16 a[230:231], v39 offset:41472
    v_mfma_f32_32x32x16_bf16 v[160:175], a[244:247], a[208:211], v[160:175]
    buffer_load_dwordx4 v23, s[24:27], s91 offen offset:3072 lds
    v_mfma_f32_32x32x16_bf16 v[176:191], a[244:247], a[212:215], v[176:191]
    v_mfma_f32_16x16x32_bf16 v[44:47], v[40:43], a[208:211], v[44:47]
    v_mfma_f32_16x16x32_bf16 v[48:51], v[40:43], a[240:243], v[48:51]
    v_mfma_f32_16x16x32_bf16 v[52:55], v[40:43], a[244:247], v[52:55]
    s_waitcnt vmcnt(22) lgkmcnt(0)
    s_barrier
    v_mfma_f32_32x32x16_bf16 v[128:143], a[224:227], a[216:219], v[128:143]
    ds_read_b64_tr_b16 a[232:233], v36 offset:49152
    ds_read_b64_tr_b16 a[234:235], v36 offset:49664
    s_add_u32 m0, s90, 98304
    s_add_u32 s91, s61, 128
    buffer_load_dwordx4 v20, s[24:27], s91 offen offset:0 lds
    v_mfma_f32_32x32x16_bf16 v[144:159], a[224:227], a[220:223], v[144:159]
    ds_read_b64_tr_b16 a[236:237], v36 offset:57344
    ds_read_b64_tr_b16 a[238:239], v36 offset:57856
    v_mfma_f32_32x32x16_bf16 v[160:175], a[228:231], a[216:219], v[160:175]
    buffer_load_dwordx4 v21, s[24:27], s91 offen offset:1024 lds
    v_mfma_f32_32x32x16_bf16 v[176:191], a[228:231], a[220:223], v[176:191]
    v_mfma_f32_16x16x32_bf16 v[44:47], v[40:43], a[216:219], v[44:47]
    s_waitcnt lgkmcnt(0)
    v_mfma_f32_32x32x16_bf16 v[192:207], a[232:235], a[0:3], 0
    ds_read_b64_tr_b16 a[240:241], v37 offset:49152
    ds_read_b64_tr_b16 a[242:243], v37 offset:49664
    buffer_load_dwordx4 v22, s[24:27], s91 offen offset:2048 lds
    v_mfma_f32_32x32x16_bf16 v[208:223], a[232:235], a[4:7], 0
    ds_read_b64_tr_b16 a[244:245], v37 offset:57344
    ds_read_b64_tr_b16 a[246:247], v37 offset:57856
    v_and_b32 v8, 15, v1
    v_lshlrev_b32 v8, 2, v8
    v_cmp_gt_u32 vcc, 16, v1
    v_mfma_f32_32x32x16_bf16 v[224:239], a[236:239], a[0:3], 0
    buffer_load_dwordx4 v23, s[24:27], s91 offen offset:3072 lds
    v_lshlrev_b32_e64 v11, 2, v1
    v_add_u32 v11, 160256, v11
    s_lshl_b32 s92, s79, 8
    s_lshl_b32 s93, s80, 7
    v_mfma_f32_32x32x16_bf16 v[240:255], a[236:239], a[4:7], 0
    s_add_u32 s92, s92, s93
    s_add_u32 s92, s92, 157696
    v_add_u32 v9, s92, v8
    v_cndmask_b32_e64 v9, v11, v9, vcc
    ds_write2_b32 v9, v44, v45 offset0:0 offset1:16
    v_mfma_f32_16x16x32_bf16 a[248:251], v[40:43], a[232:235], 0
    s_lshl_b32 s92, s79, 9
    v_mfma_f32_16x16x32_bf16 a[252:255], v[40:43], a[236:239], 0
    s_waitcnt lgkmcnt(1)
    v_mfma_f32_32x32x16_bf16 v[192:207], a[240:243], a[8:11], v[192:207]
    ds_read_b64_tr_b16 a[224:225], v38 offset:49152
    ds_read_b64_tr_b16 a[226:227], v38 offset:49664
    s_lshl_b32 s93, s80, 7
    s_add_u32 s93, s93, s92
    s_add_u32 s93, s93, 158208
    v_mfma_f32_32x32x16_bf16 v[208:223], a[240:243], a[12:15], v[208:223]
    ds_read_b64_tr_b16 a[228:229], v38 offset:57344
    ds_read_b64_tr_b16 a[230:231], v38 offset:57856
    v_add_u32 v10, s93, v8
    v_cndmask_b32_e64 v10, v11, v10, vcc
    ds_write2_b32 v10, v48, v49 offset0:0 offset1:16
    v_mfma_f32_32x32x16_bf16 v[224:239], a[244:247], a[8:11], v[224:239]
    ds_write2_b32 v10, v52, v53 offset0:64 offset1:80
    s_waitcnt vmcnt(14)
    v_readfirstlane_b32 s85, v90
    s_nop 3
    s_cmp_eq_u32 s85, 0
    s_cbranch_scc1 L_slow_nonce
L_back_nonce:
    s_lshl_b32 s96, s84, 2
    v_mfma_f32_32x32x16_bf16 v[240:255], a[244:247], a[12:15], v[240:255]
    s_add_u32 s96, s96, s78
    s_lshl_b32 s96, s96, 7
    s_lshl_b32 s97, s83, 2
    s_add_u32 s96, s96, s97
    s_waitcnt lgkmcnt(2)
    v_mfma_f32_32x32x16_bf16 v[192:207], a[224:227], a[16:19], v[192:207]
    ds_read_b64_tr_b16 a[232:233], v39 offset:49152
    ds_read_b64_tr_b16 a[234:235], v39 offset:49664
    v_mov_b32_e64 v5, s85
    buffer_store_dword v5, v3, s[36:39], s96 offen sc1
    v_mfma_f32_32x32x16_bf16 v[208:223], a[224:227], a[20:23], v[208:223]
    ds_read_b64_tr_b16 a[236:237], v39 offset:57344
    ds_read_b64_tr_b16 a[238:239], v39 offset:57856
    s_lshl_b32 s99, s2, 1
    s_add_u32 s99, s99, s80
    s_lshl_b32 s99, s99, 12
    v_mfma_f32_32x32x16_bf16 v[224:239], a[228:231], a[16:19], v[224:239]
    s_lshl_b32 s96, s79, 11
    s_add_u32 s99, s99, s96
    s_mul_i32 s98, s80, 16640
    s_add_u32 s98, s98, s96
    v_add_u32_e64 v18, 2, v2
    v_mfma_f32_32x32x16_bf16 v[240:255], a[228:231], a[20:23], v[240:255]
    v_add_u32 v19, 4, v2
    v_add_u32 v28, 6, v2
    s_mul_i32 s96, s80, 4608
    s_add_u32 s96, s96, 37376
    v_and_b32_e64 v12, 31, v1
    v_mfma_f32_16x16x32_bf16 a[248:251], v[40:43], a[224:227], a[248:251]
    v_lshlrev_b32_e64 v12, 4, v12
    v_mfma_f32_16x16x32_bf16 a[252:255], v[40:43], a[228:231], a[252:255]
    s_waitcnt lgkmcnt(0)
    s_barrier
    v_mfma_f32_32x32x16_bf16 v[192:207], a[232:235], a[24:27], v[192:207]
    ds_read_b64_tr_b16 a[240:241], v32 offset:49152
    ds_read_b64_tr_b16 a[242:243], v32 offset:49664
    v_lshrrev_b32 v8, 5, v1
    v_lshlrev_b32_e64 v8, 4, v8
    s_lshl_b32 s93, s80, 7
    v_mfma_f32_32x32x16_bf16 v[208:223], a[232:235], a[28:31], v[208:223]
    ds_read_b64_tr_b16 a[244:245], v32 offset:57344
    ds_read_b64_tr_b16 a[246:247], v32 offset:57856
    s_add_u32 s93, s93, 158208
    v_add_u32_e64 v8, s93, v8
    ds_read_b128 v[56:59], v8 offset:0
    v_mfma_f32_32x32x16_bf16 v[224:239], a[236:239], a[24:27], v[224:239]
    ds_read_b128 v[60:63], v8 offset:32
    ds_read_b128 v[64:67], v8 offset:64
    ds_read_b128 v[68:71], v8 offset:96
    ds_read_b128 v[96:99], v8 offset:512
    ds_read_b128 v[100:103], v8 offset:544
    v_mfma_f32_32x32x16_bf16 v[240:255], a[236:239], a[28:31], v[240:255]
    ds_read_b128 v[104:107], v8 offset:576
    ds_read_b128 v[108:111], v8 offset:608
    v_and_b32 v9, 31, v1
    v_lshlrev_b32_e64 v9, 2, v9
    s_waitcnt lgkmcnt(8)
    v_mfma_f32_32x32x16_bf16 v[192:207], a[240:243], a[32:35], v[192:207]
    ds_read_b64_tr_b16 a[224:225], v33 offset:49152
    ds_read_b64_tr_b16 a[226:227], v33 offset:49664
    s_lshl_b32 s92, s79, 8
    s_lshl_b32 s93, s80, 7
    s_add_u32 s92, s92, s93
    v_mfma_f32_32x32x16_bf16 v[208:223], a[240:243], a[36:39], v[208:223]
    ds_read_b64_tr_b16 a[228:229], v33 offset:57344
    ds_read_b64_tr_b16 a[230:231], v33 offset:57856
    s_add_u32 s92, s92, 157696
    v_add_u32 v9, s92, v9
    v_xor_b32 v10, 128, v9
    v_mfma_f32_32x32x16_bf16 v[224:239], a[244:247], a[32:35], v[224:239]
    ds_read_b32 v88, v9
    ds_read_b32 v89, v10
    ds_read_b128 v[72:75], v8 offset:256
    ds_read_b128 v[76:79], v8 offset:288
    ds_read_b128 v[80:83], v8 offset:320
    v_mfma_f32_32x32x16_bf16 v[240:255], a[244:247], a[36:39], v[240:255]
    ds_read_b128 v[84:87], v8 offset:352
    s_waitcnt lgkmcnt(10)
    v_add_f32 v56, v56, v96
    v_add_f32 v57, v57, v97
    v_add_f32 v58, v58, v98
    v_add_f32_e64 v59, v59, v99
    v_mfma_f32_16x16x32_bf16 a[248:251], v[40:43], a[240:243], a[248:251]
    v_add_f32_e64 v60, v60, v100
    v_mfma_f32_16x16x32_bf16 a[252:255], v[40:43], a[244:247], a[252:255]
    s_waitcnt lgkmcnt(6)
    v_mfma_f32_32x32x16_bf16 v[192:207], a[224:227], a[40:43], v[192:207]
    ds_read_b64_tr_b16 a[232:233], v34 offset:49152
    ds_read_b64_tr_b16 a[234:235], v34 offset:49664
    v_add_f32 v61, v61, v101
    v_add_f32 v62, v62, v102
    v_add_f32 v63, v63, v103
    v_mfma_f32_32x32x16_bf16 v[208:223], a[224:227], a[44:47], v[208:223]
    ds_read_b64_tr_b16 a[236:237], v34 offset:57344
    ds_read_b64_tr_b16 a[238:239], v34 offset:57856
    v_add_f32 v64, v64, v104
    v_add_f32 v65, v65, v105
    v_add_f32_e64 v66, v66, v106
    v_mfma_f32_32x32x16_bf16 v[224:239], a[228:231], a[40:43], v[224:239]
    v_add_f32 v67, v67, v107
    v_add_f32 v68, v68, v108
    v_add_f32 v69, v69, v109
    v_add_f32 v70, v70, v110
    v_add_f32_e64 v71, v71, v111
    v_mfma_f32_32x32x16_bf16 v[240:255], a[228:231], a[44:47], v[240:255]
    ds_read_b128 v[96:99], v8 offset:768
    ds_read_b128 v[100:103], v8 offset:800
    ds_read_b128 v[104:107], v8 offset:832
    ds_read_b128 v[108:111], v8 offset:864
    s_waitcnt lgkmcnt(4)
    v_mfma_f32_32x32x16_bf16 v[192:207], a[232:235], a[48:51], v[192:207]
    ds_read_b64_tr_b16 a[240:241], v35 offset:49152
    ds_read_b64_tr_b16 a[242:243], v35 offset:49664
    s_mov_b32 s92, 0x3b124925
    v_mul_f32 v88, s92, v88
    v_mul_f32_e64 v89, s92, v89
    v_mfma_f32_32x32x16_bf16 v[208:223], a[232:235], a[52:55], v[208:223]
    ds_read_b64_tr_b16 a[244:245], v35 offset:57344
    ds_read_b64_tr_b16 a[246:247], v35 offset:57856
    v_cvt_pk_bf16_f32 v9, v88, v89
    v_lshlrev_b32 v88, 16, v9
    v_and_b32 v89, s3, v9
    v_mfma_f32_32x32x16_bf16 v[224:239], a[236:239], a[48:51], v[224:239]
    v_add_u32_e64 v24, s96, v12
    v_bfe_u32 v12, v1, 3, 2
    v_and_b32_e64 v13, 7, v1
    v_mul_u32_u24 v12, 4160, v12
    v_lshl_add_u32 v12, v13, 2, v12
    v_mfma_f32_32x32x16_bf16 v[240:255], a[236:239], a[52:55], v[240:255]
    s_waitcnt lgkmcnt(7)
    v_add_f32 v72, v72, v96
    v_add_f32 v73, v73, v97
    v_add_f32 v74, v74, v98
    v_add_f32 v75, v75, v99
    s_waitcnt lgkmcnt(4)
    v_add_f32_e64 v76, v76, v100
    v_mfma_f32_16x16x32_bf16 a[248:251], v[40:43], a[232:235], a[248:251]
    v_add_f32_e64 v77, v77, v101
    v_mfma_f32_16x16x32_bf16 a[252:255], v[40:43], a[236:239], a[252:255]
    s_waitcnt lgkmcnt(0)
    s_barrier
    v_mfma_f32_32x32x16_bf16 v[192:207], a[240:243], a[56:59], v[192:207]
    ds_read_b64_tr_b16 a[224:225], v36 offset:0
    ds_read_b64_tr_b16 a[226:227], v36 offset:512
    s_add_u32 m0, s90, 131072
    s_nop 0
    buffer_load_dwordx4 v112, s[28:31], s76 offen offset:0 lds
    v_add_f32 v78, v78, v102
    v_mfma_f32_32x32x16_bf16 v[208:223], a[240:243], a[60:63], v[208:223]
    ds_read_b64_tr_b16 a[228:229], v36 offset:8192
    ds_read_b64_tr_b16 a[230:231], v36 offset:8704
    v_add_f32 v79, v79, v103
    v_add_f32 v80, v80, v104
    v_add_f32_e64 v81, v81, v105
    v_mfma_f32_32x32x16_bf16 v[224:239], a[244:247], a[56:59], v[224:239]
    buffer_load_dwordx4 v113, s[28:31], s76 offen offset:1024 lds
    v_add_f32 v82, v82, v106
    v_add_f32 v83, v83, v107
    v_add_f32 v84, v84, v108
    v_add_f32 v85, v85, v109
    v_mfma_f32_32x32x16_bf16 v[240:255], a[244:247], a[60:63], v[240:255]
    v_add_f32 v86, v86, v110
    v_add_f32_e64 v87, v87, v111
    v_fma_f32 v128, -v88, v56, v128
    v_fma_f32 v160, -v88, v72, v160
    s_waitcnt lgkmcnt(0)
    v_mfma_f32_32x32x16_bf16 v[192:207], a[224:227], a[64:67], v[192:207]
    ds_read_b64_tr_b16 a[232:233], v37 offset:0
    ds_read_b64_tr_b16 a[234:235], v37 offset:512
    buffer_load_dwordx4 v114, s[28:31], s76 offen offset:2048 lds
    v_fma_f32 v129, -v88, v57, v129
    v_fma_f32 v161, -v88, v73, v161
    v_mfma_f32_32x32x16_bf16 v[208:223], a[224:227], a[68:71], v[208:223]
    ds_read_b64_tr_b16 a[236:237], v37 offset:8192
    ds_read_b64_tr_b16 a[238:239], v37 offset:8704
    v_fma_f32 v130, -v88, v58, v130
    v_fma_f32 v162, -v88, v74, v162
    v_fma_f32 v131, -v88, v59, v131
    v_mfma_f32_32x32x16_bf16 v[224:239], a[228:231], a[64:67], v[224:239]
    buffer_load_dwordx4 v115, s[28:31], s76 offen offset:3072 lds
    s_add_u32 m0, s90, 114688
    v_fma_f32 v163, -v88, v75, v163
    v_fma_f32 v132, -v88, v60, v132
    v_fma_f32 v164, -v88, v76, v164
    v_mfma_f32_32x32x16_bf16 v[240:255], a[228:231], a[68:71], v[240:255]
    v_fma_f32 v133, -v88, v61, v133
    v_fma_f32 v165, -v88, v77, v165
    v_fma_f32 v134, -v88, v62, v134
    v_fma_f32 v166, -v88, v78, v166
    v_fma_f32 v135, -v88, v63, v135
    v_mfma_f32_16x16x32_bf16 a[248:251], v[40:43], a[224:227], a[248:251]
    buffer_load_dwordx4 v112, s[28:31], s75 offen offset:0 lds
    v_mfma_f32_16x16x32_bf16 a[252:255], v[40:43], a[228:231], a[252:255]
    s_waitcnt lgkmcnt(0)
    v_mfma_f32_32x32x16_bf16 v[192:207], a[232:235], a[72:75], v[192:207]
    ds_read_b64_tr_b16 a[240:241], v38 offset:0
    ds_read_b64_tr_b16 a[242:243], v38 offset:512
    v_fma_f32 v167, -v88, v79, v167
    v_max_f32 v128, 0, v128
    v_max_f32_e64 v129, 0, v129
    v_mfma_f32_32x32x16_bf16 v[208:223], a[232:235], a[76:79], v[208:223]
    ds_read_b64_tr_b16 a[244:245], v38 offset:8192
    ds_read_b64_tr_b16 a[246:247], v38 offset:8704
    buffer_load_dwordx4 v113, s[28:31], s75 offen offset:1024 lds
    v_max_f32 v130, 0, v130
    v_max_f32 v131, 0, v131
    v_mfma_f32_32x32x16_bf16 v[224:239], a[236:239], a[72:75], v[224:239]
    v_max_f32 v132, 0, v132
    v_max_f32 v133, 0, v133
    v_max_f32 v134, 0, v134
    v_max_f32 v135, 0, v135
    v_mul_f32_e64 v128, v128, v160
    v_mfma_f32_32x32x16_bf16 v[240:255], a[236:239], a[76:79], v[240:255]
    buffer_load_dwordx4 v114, s[28:31], s75 offen offset:2048 lds
    v_mul_f32 v129, v129, v161
    v_mul_f32 v130, v130, v162
    v_mul_f32 v131, v131, v163
    s_waitcnt lgkmcnt(0)
    v_mfma_f32_32x32x16_bf16 v[192:207], a[240:243], a[80:83], v[192:207]
    ds_read_b64_tr_b16 a[224:225], v39 offset:0
    ds_read_b64_tr_b16 a[226:227], v39 offset:512
    v_mul_f32 v132, v132, v164
    v_mul_f32 v133, v133, v165
    v_mul_f32_e64 v134, v134, v166
    v_mfma_f32_32x32x16_bf16 v[208:223], a[240:243], a[84:87], v[208:223]
    ds_read_b64_tr_b16 a[228:229], v39 offset:8192
    ds_read_b64_tr_b16 a[230:231], v39 offset:8704
    buffer_load_dwordx4 v115, s[28:31], s75 offen offset:3072 lds
    s_add_u32 m0, s90, 49152
    v_mul_f32_e64 v135, v135, v167
    v_mfma_f32_32x32x16_bf16 v[224:239], a[244:247], a[80:83], v[224:239]
    v_cvt_pk_bf16_f32 v96, v128, v129
    v_cvt_pk_bf16_f32 v97, v130, v131
    v_cvt_pk_bf16_f32 v98, v132, v133
    v_cvt_pk_bf16_f32 v99, v134, v135
    v_fma_f32 v136, -v88, v64, v136
    v_mfma_f32_32x32x16_bf16 v[240:255], a[244:247], a[84:87], v[240:255]
    buffer_load_dwordx4 v112, s[28:31], 0 offen offset:0 lds
    v_fma_f32 v168, -v88, v80, v168
    v_fma_f32 v137, -v88, v65, v137
    v_fma_f32 v169, -v88, v81, v169
    v_fma_f32 v138, -v88, v66, v138
    v_mfma_f32_16x16x32_bf16 a[248:251], v[40:43], a[240:243], a[248:251]
    v_fma_f32 v170, -v88, v82, v170
    v_mfma_f32_16x16x32_bf16 a[252:255], v[40:43], a[244:247], a[252:255]
    s_waitcnt vmcnt(22) lgkmcnt(0)
    s_barrier
    v_mfma_f32_32x32x16_bf16 v[192:207], a[224:227], a[88:91], v[192:207]
    ds_read_b64_tr_b16 a[232:233], v32 offset:0
    ds_read_b64_tr_b16 a[234:235], v32 offset:512
    buffer_load_dwordx4 v113, s[28:31], 0 offen offset:1024 lds
    v_fma_f32 v139, -v88, v67, v139
    v_fma_f32 v171, -v88, v83, v171
    v_mfma_f32_32x32x16_bf16 v[208:223], a[224:227], a[92:95], v[208:223]
    ds_read_b64_tr_b16 a[236:237], v32 offset:8192
    ds_read_b64_tr_b16 a[238:239], v32 offset:8704
    s_add_u32 s92, s62, 0
    s_mul_i32 s96, s80, 16640
    s_add_u32 s96, s96, 0
    v_mfma_f32_32x32x16_bf16 v[224:239], a[228:231], a[88:91], v[224:239]
    buffer_store_dwordx4 v[96:99], v2, s[36:39], s92 offen offset:0 sc1
    v_fma_f32 v140, -v88, v68, v140
    v_fma_f32 v172, -v88, v84, v172
    v_fma_f32 v141, -v88, v69, v141
    v_fma_f32 v173, -v88, v85, v173
    v_mfma_f32_32x32x16_bf16 v[240:255], a[228:231], a[92:95], v[240:255]
    v_fma_f32 v142, -v88, v70, v142
    v_fma_f32 v174, -v88, v86, v174
    v_fma_f32 v143, -v88, v71, v143
    v_fma_f32 v175, -v88, v87, v175
    s_waitcnt lgkmcnt(0)
    v_mfma_f32_32x32x16_bf16 v[192:207], a[232:235], a[96:99], v[192:207]
    ds_read_b64_tr_b16 a[240:241], v33 offset:0
    ds_read_b64_tr_b16 a[242:243], v33 offset:512
    buffer_load_dwordx4 v114, s[28:31], 0 offen offset:2048 lds
    v_max_f32 v136, 0, v136
    v_max_f32_e64 v137, 0, v137
    v_mfma_f32_32x32x16_bf16 v[208:223], a[232:235], a[100:103], v[208:223]
    ds_read_b64_tr_b16 a[244:245], v33 offset:8192
    ds_read_b64_tr_b16 a[246:247], v33 offset:8704
    v_max_f32 v138, 0, v138
    v_max_f32 v139, 0, v139
    v_max_f32_e64 v140, 0, v140
    v_mfma_f32_32x32x16_bf16 v[224:239], a[236:239], a[96:99], v[224:239]
    buffer_load_dwordx4 v115, s[28:31], 0 offen offset:3072 lds
    s_add_u32 m0, s90, 65536
    v_max_f32 v141, 0, v141
    v_max_f32 v142, 0, v142
    v_max_f32_e64 v143, 0, v143
    v_mfma_f32_32x32x16_bf16 v[240:255], a[236:239], a[100:103], v[240:255]
    v_mul_f32 v136, v136, v168
    v_mul_f32 v137, v137, v169
    v_mul_f32 v138, v138, v170
    v_mul_f32 v139, v139, v171
    v_mul_f32_e64 v140, v140, v172
    v_mfma_f32_16x16x32_bf16 a[248:251], v[40:43], a[232:235], a[248:251]
    buffer_load_dwordx4 v112, s[28:31], s72 offen offset:0 lds
    v_mfma_f32_16x16x32_bf16 a[252:255], v[40:43], a[236:239], a[252:255]
    s_waitcnt lgkmcnt(0)
    v_mfma_f32_32x32x16_bf16 v[192:207], a[240:243], a[104:107], v[192:207]
    ds_read_b64_tr_b16 a[224:225], v34 offset:0
    ds_read_b64_tr_b16 a[226:227], v34 offset:512
    v_mul_f32 v141, v141, v173
    v_mul_f32 v142, v142, v174
    v_mul_f32_e64 v143, v143, v175
    v_mfma_f32_32x32x16_bf16 v[208:223], a[240:243], a[108:111], v[208:223]
    ds_read_b64_tr_b16 a[228:229], v34 offset:8192
    ds_read_b64_tr_b16 a[230:231], v34 offset:8704
    buffer_load_dwordx4 v113, s[28:31], s72 offen offset:1024 lds
    v_cvt_pk_bf16_f32 v100, v136, v137
    v_cvt_pk_bf16_f32 v101, v138, v139
    v_mfma_f32_32x32x16_bf16 v[224:239], a[244:247], a[104:107], v[224:239]
    v_cvt_pk_bf16_f32 v102, v140, v141
    v_cvt_pk_bf16_f32 v103, v142, v143
    v_fma_f32 v144, -v89, v56, v144
    v_fma_f32 v176, -v89, v72, v176
    v_fma_f32 v145, -v89, v57, v145
    v_mfma_f32_32x32x16_bf16 v[240:255], a[244:247], a[108:111], v[240:255]
    buffer_load_dwordx4 v114, s[28:31], s72 offen offset:2048 lds
    v_fma_f32 v177, -v89, v73, v177
    v_fma_f32 v146, -v89, v58, v146
    v_fma_f32 v178, -v89, v74, v178
    s_waitcnt lgkmcnt(0)
    v_mfma_f32_32x32x16_bf16 v[192:207], a[224:227], a[112:115], v[192:207]
    ds_read_b64_tr_b16 a[232:233], v35 offset:0
    ds_read_b64_tr_b16 a[234:235], v35 offset:512
    v_fma_f32 v147, -v89, v59, v147
    v_fma_f32 v179, -v89, v75, v179
    s_add_u32 s92, s62, 0
    v_mfma_f32_32x32x16_bf16 v[208:223], a[224:227], a[116:119], v[208:223]
    ds_read_b64_tr_b16 a[236:237], v35 offset:8192
    ds_read_b64_tr_b16 a[238:239], v35 offset:8704
    buffer_store_dwordx4 v[100:103], v2, s[36:39], s92 offen offset:1024 sc1
    v_fma_f32 v148, -v89, v60, v148
    v_fma_f32 v180, -v89, v76, v180
    v_mfma_f32_32x32x16_bf16 v[224:239], a[228:231], a[112:115], v[224:239]
    v_fma_f32 v149, -v89, v61, v149
    v_fma_f32 v181, -v89, v77, v181
    v_fma_f32 v150, -v89, v62, v150
    v_fma_f32 v182, -v89, v78, v182
    v_fma_f32 v151, -v89, v63, v151
    v_mfma_f32_32x32x16_bf16 v[240:255], a[228:231], a[116:119], v[240:255]
    buffer_load_dwordx4 v115, s[28:31], s72 offen offset:3072 lds
    v_fma_f32 v183, -v89, v79, v183
    v_max_f32 v144, 0, v144
    v_max_f32 v145, 0, v145
    v_max_f32 v146, 0, v146
    v_mfma_f32_16x16x32_bf16 a[248:251], v[40:43], a[224:227], a[248:251]
    v_max_f32_e64 v147, 0, v147
    v_mfma_f32_16x16x32_bf16 a[252:255], v[40:43], a[228:231], a[252:255]
    s_waitcnt vmcnt(27) lgkmcnt(0)
    s_barrier
    v_mfma_f32_32x32x16_bf16 v[192:207], a[232:235], a[120:123], v[192:207]
    ds_read_b64_tr_b16 a[240:241], v36 offset:16384
    ds_read_b64_tr_b16 a[242:243], v36 offset:16896
    v_max_f32 v148, 0, v148
    v_max_f32 v149, 0, v149
    v_max_f32_e64 v150, 0, v150
    v_mfma_f32_32x32x16_bf16 v[208:223], a[232:235], a[124:127], v[208:223]
    ds_read_b64_tr_b16 a[244:245], v36 offset:24576
    ds_read_b64_tr_b16 a[246:247], v36 offset:25088
    v_max_f32 v151, 0, v151
    v_mul_f32 v144, v144, v176
    v_mul_f32_e64 v145, v145, v177
    v_mfma_f32_32x32x16_bf16 v[224:239], a[236:239], a[120:123], v[224:239]
    v_mul_f32 v146, v146, v178
    v_mul_f32 v147, v147, v179
    v_mul_f32 v148, v148, v180
    v_mul_f32 v149, v149, v181
    v_mul_f32_e64 v150, v150, v182
    v_mfma_f32_32x32x16_bf16 v[240:255], a[236:239], a[124:127], v[240:255]
    v_mul_f32_e64 v151, v151, v183
    v_cvt_pk_bf16_f32 v104, v144, v145
    v_cvt_pk_bf16_f32 v105, v146, v147
    v_cvt_pk_bf16_f32 v106, v148, v149
    s_waitcnt lgkmcnt(0)
    v_mfma_f32_32x32x16_bf16 v[192:207], a[240:243], a[128:131], v[192:207]
    ds_read_b64_tr_b16 a[224:225], v37 offset:16384
    ds_read_b64_tr_b16 a[226:227], v37 offset:16896
    v_cvt_pk_bf16_f32 v107, v150, v151
    v_fma_f32 v152, -v89, v64, v152
    v_fma_f32 v184, -v89, v80, v184
    v_mfma_f32_32x32x16_bf16 v[208:223], a[240:243], a[132:135], v[208:223]
    ds_read_b64_tr_b16 a[228:229], v37 offset:24576
    ds_read_b64_tr_b16 a[230:231], v37 offset:25088
    v_fma_f32 v153, -v89, v65, v153
    v_fma_f32 v185, -v89, v81, v185
    v_fma_f32 v154, -v89, v66, v154
    v_mfma_f32_32x32x16_bf16 v[224:239], a[244:247], a[128:131], v[224:239]
    v_fma_f32 v186, -v89, v82, v186
    v_fma_f32 v155, -v89, v67, v155
    v_fma_f32 v187, -v89, v83, v187
    s_add_u32 s92, s63, 0
    buffer_store_dwordx4 v[104:107], v2, s[36:39], s92 offen offset:0 sc1
    v_mfma_f32_32x32x16_bf16 v[240:255], a[244:247], a[132:135], v[240:255]
    v_fma_f32 v156, -v89, v68, v156
    v_fma_f32 v188, -v89, v84, v188
    v_fma_f32 v157, -v89, v69, v157
    v_fma_f32 v189, -v89, v85, v189
    v_fma_f32 v158, -v89, v70, v158
    v_mfma_f32_16x16x32_bf16 a[248:251], v[40:43], a[240:243], a[248:251]
    v_fma_f32 v190, -v89, v86, v190
    v_mfma_f32_16x16x32_bf16 a[252:255], v[40:43], a[244:247], a[252:255]
    s_waitcnt lgkmcnt(0)
    v_mfma_f32_32x32x16_bf16 v[192:207], a[224:227], a[136:139], v[192:207]
    ds_read_b64_tr_b16 a[232:233], v38 offset:16384
    ds_read_b64_tr_b16 a[234:235], v38 offset:16896
    v_fma_f32 v159, -v89, v71, v159
    v_fma_f32 v191, -v89, v87, v191
    v_max_f32 v152, 0, v152
    v_mfma_f32_32x32x16_bf16 v[208:223], a[224:227], a[140:143], v[208:223]
    ds_read_b64_tr_b16 a[236:237], v38 offset:24576
    ds_read_b64_tr_b16 a[238:239], v38 offset:25088
    v_max_f32 v153, 0, v153
    v_max_f32 v154, 0, v154
    v_max_f32_e64 v155, 0, v155
    v_mfma_f32_32x32x16_bf16 v[224:239], a[228:231], a[136:139], v[224:239]
    v_max_f32 v156, 0, v156
    v_max_f32 v157, 0, v157
    v_max_f32 v158, 0, v158
    v_max_f32 v159, 0, v159
    v_mul_f32_e64 v152, v152, v184
    v_mfma_f32_32x32x16_bf16 v[240:255], a[228:231], a[140:143], v[240:255]
    v_mul_f32 v153, v153, v185
    v_mul_f32 v154, v154, v186
    v_mul_f32 v155, v155, v187
    v_mul_f32_e64 v156, v156, v188
    s_waitcnt lgkmcnt(0)
    v_mfma_f32_32x32x16_bf16 v[192:207], a[232:235], a[144:147], v[192:207]
    ds_read_b64_tr_b16 a[240:241], v39 offset:16384
    ds_read_b64_tr_b16 a[242:243], v39 offset:16896
    v_mul_f32 v157, v157, v189
    v_mul_f32 v158, v158, v190
    v_mul_f32_e64 v159, v159, v191
    v_mfma_f32_32x32x16_bf16 v[208:223], a[232:235], a[148:151], v[208:223]
    ds_read_b64_tr_b16 a[244:245], v39 offset:24576
    ds_read_b64_tr_b16 a[246:247], v39 offset:25088
    v_cvt_pk_bf16_f32 v108, v152, v153
    v_cvt_pk_bf16_f32 v109, v154, v155
    v_cvt_pk_bf16_f32 v110, v156, v157
    v_mfma_f32_32x32x16_bf16 v[224:239], a[236:239], a[144:147], v[224:239]
    v_cvt_pk_bf16_f32 v111, v158, v159
    v_add_u32 v25, s96, v12
    v_and_b32 v12, 15, v1
    v_lshrrev_b32 v13, 4, v1
    v_lshlrev_b32_e64 v14, 5, v12
    v_mfma_f32_32x32x16_bf16 v[240:255], a[236:239], a[148:151], v[240:255]
    s_add_u32 s92, s63, 0
    buffer_store_dwordx4 v[108:111], v2, s[36:39], s92 offen offset:1024 sc1
    s_lshl_b32 s92, s2, 1
    s_add_u32 s92, s92, s80
    s_lshl_b32 s93, s92, 1
    v_mfma_f32_16x16x32_bf16 a[248:251], v[40:43], a[232:235], a[248:251]
    v_mov_b32_e64 v4, 0
    v_mfma_f32_16x16x32_bf16 a[252:255], v[40:43], a[236:239], a[252:255]
    s_waitcnt vmcnt(25) lgkmcnt(0)
    s_barrier
    v_mfma_f32_32x32x16_bf16 v[192:207], a[240:243], a[152:155], v[192:207]
    ds_read_b64_tr_b16 a[224:225], v32 offset:16384
    ds_read_b64_tr_b16 a[226:227], v32 offset:16896
    buffer_load_ushort v162, v4, s[44:47], s93 offen
    s_add_u32 m0, s90, 81920
    s_nop 0
    buffer_load_dwordx4 v112, s[28:31], s73 offen offset:0 lds
    v_mfma_f32_32x32x16_bf16 v[208:223], a[240:243], a[156:159], v[208:223]
    ds_read_b64_tr_b16 a[228:229], v32 offset:24576
    ds_read_b64_tr_b16 a[230:231], v32 offset:25088
    s_lshl_b32 s92, s92, 12
    v_lshl_add_u32 v27, v13, 3, v14
    v_lshlrev_b32_e64 v7, 4, v13
    v_mfma_f32_32x32x16_bf16 v[224:239], a[244:247], a[152:155], v[224:239]
    buffer_load_dwordx2 v[160:161], v4, s[20:23], s92 offen
    s_lshl_b32 s92, s2, 1
    s_add_u32 s92, s92, s80
    s_lshr_b32 s93, s92, 6
    s_lshl_b32 s93, s93, 2
    v_mfma_f32_32x32x16_bf16 v[240:255], a[244:247], a[156:159], v[240:255]
    buffer_load_dwordx4 v113, s[28:31], s73 offen offset:1024 lds
    s_bfe_u32 s92, s92, 0x20004
    s_add_u32 s92, s92, s93
    s_lshl_b32 s92, s92, 7
    s_waitcnt lgkmcnt(0)
    v_mfma_f32_32x32x16_bf16 v[192:207], a[224:227], a[160:163], v[192:207]
    ds_read_b64_tr_b16 a[232:233], v33 offset:16384
    ds_read_b64_tr_b16 a[234:235], v33 offset:16896
    s_xor_b32 s93, s79, 1
    s_lshl_b32 s93, s93, 6
    s_add_u32 s101, s92, s93
    v_mfma_f32_32x32x16_bf16 v[208:223], a[224:227], a[164:167], v[208:223]
    ds_read_b64_tr_b16 a[236:237], v33 offset:24576
    ds_read_b64_tr_b16 a[238:239], v33 offset:25088
    buffer_load_dwordx4 v114, s[28:31], s73 offen offset:2048 lds
    v_and_b32 v91, 15, v1
    v_lshlrev_b32_e64 v91, 2, v91
    v_mfma_f32_32x32x16_bf16 v[224:239], a[228:231], a[160:163], v[224:239]
    v_sub_u32_e64 v7, v7, v14
    s_mul_i32 s96, s80, 4608
    s_lshl_b32 s97, s79, 8
    s_add_u32 s96, s96, s97
    s_add_u32 s96, s96, 33760
    v_mfma_f32_32x32x16_bf16 v[240:255], a[228:231], a[164:167], v[240:255]
    buffer_load_dwordx4 v115, s[28:31], s73 offen offset:3072 lds
    v_add_u32 v16, s96, v7
    v_add_u32 v14, 1, v12
    v_and_b32 v7, 3, v14
    v_sub_u32 v14, v14, v7
    v_mfma_f32_16x16x32_bf16 a[248:251], v[40:43], a[224:227], a[248:251]
    v_lshlrev_b32_e64 v14, 1, v14
    v_mfma_f32_16x16x32_bf16 a[252:255], v[40:43], a[228:231], a[252:255]
    s_waitcnt lgkmcnt(0)
    v_mfma_f32_32x32x16_bf16 v[192:207], a[232:235], a[168:171], v[192:207]
    ds_read_b64_tr_b16 a[240:241], v34 offset:16384
    ds_read_b64_tr_b16 a[242:243], v34 offset:16896
    v_mul_u32_u24 v7, 4160, v7
    v_add_u32 v14, v14, v7
    v_lshl_add_u32 v14, v13, 4, v14
    v_mfma_f32_32x32x16_bf16 v[208:223], a[232:235], a[172:175], v[208:223]
    ds_read_b64_tr_b16 a[244:245], v34 offset:24576
    ds_read_b64_tr_b16 a[246:247], v34 offset:25088
    s_mul_i32 s96, s80, 16640
    s_add_u32 s96, s96, s97
    s_add_u32 s96, s96, 0
    v_mfma_f32_32x32x16_bf16 v[224:239], a[236:239], a[168:171], v[224:239]
    v_add_u32_e64 v17, s96, v14
    s_mul_i32 s96, s80, 4608
    s_lshl_b32 s97, s79, 11
    s_sub_u32 s96, s96, s97
    s_add_u32 s96, s96, 35832
    v_mfma_f32_32x32x16_bf16 v[240:255], a[236:239], a[172:175], v[240:255]
    buffer_load_dword v92, v91, s[36:39], s101 offen sc1
    v_sub_u32 v26, s96, v27
    s_waitcnt lgkmcnt(0)
    v_mfma_f32_32x32x16_bf16 v[192:207], a[240:243], a[176:179], v[192:207]
    ds_read_b64_tr_b16 a[224:225], v35 offset:16384
    ds_read_b64_tr_b16 a[226:227], v35 offset:16896
    v_mfma_f32_32x32x16_bf16 v[208:223], a[240:243], a[180:183], v[208:223]
    ds_read_b64_tr_b16 a[228:229], v35 offset:24576
    ds_read_b64_tr_b16 a[230:231], v35 offset:25088
    v_mfma_f32_32x32x16_bf16 v[224:239], a[244:247], a[176:179], v[224:239]
    v_mfma_f32_32x32x16_bf16 v[240:255], a[244:247], a[180:183], v[240:255]
    v_mfma_f32_16x16x32_bf16 a[248:251], v[40:43], a[240:243], a[248:251]
    v_mfma_f32_16x16x32_bf16 a[252:255], v[40:43], a[244:247], a[252:255]
    s_waitcnt vmcnt(28) lgkmcnt(0)
    s_barrier
    v_mfma_f32_32x32x16_bf16 v[192:207], a[224:227], a[184:187], v[192:207]
    ds_read_b64_tr_b16 a[232:233], v36 offset:32768
    ds_read_b64_tr_b16 a[234:235], v36 offset:33280
    s_add_u32 m0, s98, 32
    s_nop 0
    buffer_load_dwordx4 v2, s[20:23], s99 offen offset:0 lds
    v_and_b32_e64 v47, 31, v1
    v_mfma_f32_32x32x16_bf16 v[208:223], a[224:227], a[188:191], v[208:223]
    ds_read_b64_tr_b16 a[236:237], v36 offset:40960
    ds_read_b64_tr_b16 a[238:239], v36 offset:41472
    v_mov_b32_e64 v44, 0
    v_mfma_f32_32x32x16_bf16 v[224:239], a[228:231], a[184:187], v[224:239]
    buffer_load_dwordx4 v2, s[20:23], s99 offen offset:1024 lds
    s_add_u32 m0, s98, 4192
    v_mfma_f32_32x32x16_bf16 v[240:255], a[228:231], a[188:191], v[240:255]
    s_waitcnt lgkmcnt(0)
    v_mfma_f32_32x32x16_bf16 v[192:207], a[232:235], a[192:195], v[192:207]
    ds_read_b64_tr_b16 a[240:241], v37 offset:32768
    ds_read_b64_tr_b16 a[242:243], v37 offset:33280
    buffer_load_dwordx4 v18, s[20:23], s99 offen offset:0 lds
    v_mfma_f32_32x32x16_bf16 v[208:223], a[232:235], a[196:199], v[208:223]
    ds_read_b64_tr_b16 a[244:245], v37 offset:40960
    ds_read_b64_tr_b16 a[246:247], v37 offset:41472
    v_mfma_f32_32x32x16_bf16 v[224:239], a[236:239], a[192:195], v[224:239]
    buffer_load_dwordx4 v18, s[20:23], s99 offen offset:1024 lds
    s_add_u32 m0, s98, 8352
    v_mfma_f32_32x32x16_bf16 v[240:255], a[236:239], a[196:199], v[240:255]
    v_mfma_f32_16x16x32_bf16 a[248:251], v[40:43], a[232:235], a[248:251]
    buffer_load_dwordx4 v19, s[20:23], s99 offen offset:0 lds
    v_mfma_f32_16x16x32_bf16 a[252:255], v[40:43], a[236:239], a[252:255]
    s_waitcnt lgkmcnt(0)
    v_mfma_f32_32x32x16_bf16 v[192:207], a[240:243], a[200:203], v[192:207]
    ds_read_b64_tr_b16 a[224:225], v38 offset:32768
    ds_read_b64_tr_b16 a[226:227], v38 offset:33280
    v_mfma_f32_32x32x16_bf16 v[208:223], a[240:243], a[204:207], v[208:223]
    ds_read_b64_tr_b16 a[228:229], v38 offset:40960
    ds_read_b64_tr_b16 a[230:231], v38 offset:41472
    buffer_load_dwordx4 v19, s[20:23], s99 offen offset:1024 lds
    s_add_u32 m0, s98, 12512
    v_mfma_f32_32x32x16_bf16 v[224:239], a[244:247], a[200:203], v[224:239]
    v_mfma_f32_32x32x16_bf16 v[240:255], a[244:247], a[204:207], v[240:255]
    buffer_load_dwordx4 v28, s[20:23], s99 offen offset:0 lds
    s_waitcnt lgkmcnt(0)
    v_mfma_f32_32x32x16_bf16 v[192:207], a[224:227], a[208:211], v[192:207]
    ds_read_b64_tr_b16 a[232:233], v39 offset:32768
    ds_read_b64_tr_b16 a[234:235], v39 offset:33280
    v_mfma_f32_32x32x16_bf16 v[208:223], a[224:227], a[212:215], v[208:223]
    ds_read_b64_tr_b16 a[236:237], v39 offset:40960
    ds_read_b64_tr_b16 a[238:239], v39 offset:41472
    buffer_load_dwordx4 v28, s[20:23], s99 offen offset:1024 lds
    v_mfma_f32_32x32x16_bf16 v[224:239], a[228:231], a[208:211], v[224:239]
    v_mfma_f32_32x32x16_bf16 v[240:255], a[228:231], a[212:215], v[240:255]
    s_waitcnt vmcnt(12)
    v_lshlrev_b32_e64 v45, 16, v160
    v_alignbit_b32 v46, v161, v160, 16
    v_cmp_eq_u32 vcc, 15, v47
    s_nop 1
    v_cndmask_b32 v44, v44, v45, vcc
    v_cmp_eq_u32 vcc, 23, v47
    v_mfma_f32_16x16x32_bf16 a[248:251], v[40:43], a[224:227], a[248:251]
    s_nop 0
    v_cndmask_b32_e64 v44, v44, v160, vcc
    v_mfma_f32_16x16x32_bf16 a[252:255], v[40:43], a[228:231], a[252:255]
    s_waitcnt lgkmcnt(0)
    v_mfma_f32_32x32x16_bf16 v[192:207], a[232:235], a[216:219], v[192:207]
    v_cmp_eq_u32 vcc, 31, v47
    s_nop 1
    v_cndmask_b32 v44, v44, v46, vcc
    v_cmp_eq_u32 vcc, 30, v47
    s_nop 1
    v_cndmask_b32 v44, v44, v45, vcc
    v_mov_b32_e64 v48, 0
    v_mfma_f32_32x32x16_bf16 v[208:223], a[232:235], a[220:223], v[208:223]
    v_mov_b32 v49, 0
    v_mov_b32 v50, 0
    v_mov_b32 v51, 0
    v_mov_b32 v95, v162
    ds_write_b32 v25, v44
    v_mfma_f32_32x32x16_bf16 v[224:239], a[236:239], a[216:219], v[224:239]
    ds_write_b128 v24, v[48:51]
    v_mfma_f32_32x32x16_bf16 v[240:255], a[236:239], a[220:223], v[240:255]
    s_nop 3
    v_and_b32 v8, 15, v1
    v_lshlrev_b32 v8, 2, v8
    v_cmp_gt_u32 vcc, 16, v1
    v_lshlrev_b32_e64 v11, 2, v1
    v_add_u32 v11, 160256, v11
    s_lshl_b32 s92, s79, 9
    s_lshl_b32 s93, s80, 7
    s_add_u32 s93, s93, s92
    s_add_u32 s93, s93, 159232
    v_add_u32 v10, s93, v8
    v_cndmask_b32_e64 v10, v11, v10, vcc
    ds_write2_b32 v10, a248, a249 offset0:0 offset1:16
    ds_write2_b32 v10, a252, a253 offset0:64 offset1:80
    s_waitcnt vmcnt(8)
    v_cmp_ne_u32 vcc, s85, v92
    s_nop 3
    s_cmp_lg_u64 vcc, 0
    s_cbranch_scc1 L_slow_kv
L_back_kv:
    s_mul_i32 s92, s80, 4608
    s_lshl_b32 s93, s79, 11
    s_add_u32 s92, s92, s93
    s_add_u32 m0, s92, 33280
    s_add_u32 s92, s99, 1048576
    buffer_load_dwordx4 v2, s[36:39], s92 offen offset:0 sc1 lds
    buffer_load_dwordx4 v2, s[36:39], s92 offen offset:1024 sc1 lds
    s_lshl_b32 s92, s81, 3
    s_add_u32 s92, s92, s78
    s_lshl_b32 s92, s92, 6
    s_lshl_b32 s93, s82, 2
    s_add_u32 s92, s92, s93
    s_add_u32 s92, s92, 4096
    v_mov_b32_e64 v5, s85
    buffer_store_dword v5, v3, s[36:39], s92 offen sc1
    s_waitcnt lgkmcnt(0)
    s_barrier
    v_lshrrev_b32 v8, 5, v1
    v_lshlrev_b32_e64 v8, 4, v8
    s_lshl_b32 s93, s80, 7
    s_add_u32 s93, s93, 159232
    v_add_u32_e64 v8, s93, v8
    ds_read_b128 v[56:59], v8 offset:0
    ds_read_b128 v[60:63], v8 offset:32
    ds_read_b128 v[64:67], v8 offset:64
    ds_read_b128 v[68:71], v8 offset:96
    ds_read_b128 v[96:99], v8 offset:512
    ds_read_b128 v[100:103], v8 offset:544
    ds_read_b128 v[104:107], v8 offset:576
    ds_read_b128 v[108:111], v8 offset:608
    ds_read_b128 v[72:75], v8 offset:256
    ds_read_b128 v[76:79], v8 offset:288
    ds_read_b128 v[80:83], v8 offset:320
    ds_read_b128 v[84:87], v8 offset:352
    s_waitcnt lgkmcnt(7)
    v_add_f32 v56, v56, v96
    v_add_f32 v57, v57, v97
    v_add_f32 v58, v58, v98
    v_add_f32 v59, v59, v99
    s_waitcnt lgkmcnt(6)
    v_add_f32 v60, v60, v100
    v_add_f32 v61, v61, v101
    v_add_f32 v62, v62, v102
    v_add_f32 v63, v63, v103
    s_waitcnt lgkmcnt(5)
    v_add_f32 v64, v64, v104
    v_add_f32 v65, v65, v105
    v_add_f32 v66, v66, v106
    v_add_f32 v67, v67, v107
    s_waitcnt lgkmcnt(4)
    v_add_f32 v68, v68, v108
    v_add_f32 v69, v69, v109
    v_add_f32 v70, v70, v110
    v_add_f32 v71, v71, v111
    ds_read_b128 v[96:99], v8 offset:768
    ds_read_b128 v[100:103], v8 offset:800
    ds_read_b128 v[104:107], v8 offset:832
    ds_read_b128 v[108:111], v8 offset:864
    s_waitcnt lgkmcnt(3)
    v_add_f32 v72, v72, v96
    v_add_f32 v73, v73, v97
    v_add_f32 v74, v74, v98
    v_add_f32 v75, v75, v99
    s_waitcnt lgkmcnt(2)
    v_add_f32 v76, v76, v100
    v_add_f32 v77, v77, v101
    v_add_f32 v78, v78, v102
    v_add_f32 v79, v79, v103
    s_waitcnt lgkmcnt(1)
    v_add_f32 v80, v80, v104
    v_add_f32 v81, v81, v105
    v_add_f32 v82, v82, v106
    v_add_f32 v83, v83, v107
    s_waitcnt lgkmcnt(0)
    v_add_f32 v84, v84, v108
    v_add_f32 v85, v85, v109
    v_add_f32 v86, v86, v110
    v_add_f32_e64 v87, v87, v111
    ds_read_b64_tr_b16 a[80:81], v122 offset:16384
    ds_read_b64_tr_b16 a[82:83], v122 offset:17408
    ds_read_b64_tr_b16 a[84:85], v123 offset:16384
    ds_read_b64_tr_b16 a[86:87], v123 offset:17408
    ds_read_b64_tr_b16 a[88:89], v122 offset:18432
    ds_read_b64_tr_b16 a[90:91], v122 offset:19456
    ds_read_b64_tr_b16 a[92:93], v123 offset:18432
    ds_read_b64_tr_b16 a[94:95], v123 offset:19456
    ds_read_b64_tr_b16 a[64:65], v122 offset:0
    ds_read_b64_tr_b16 a[66:67], v122 offset:1024
    ds_read_b64_tr_b16 a[68:69], v123 offset:0
    ds_read_b64_tr_b16 a[70:71], v123 offset:1024
    ds_read_b64_tr_b16 a[72:73], v122 offset:2048
    ds_read_b64_tr_b16 a[74:75], v122 offset:3072
    ds_read_b64_tr_b16 a[76:77], v123 offset:2048
    ds_read_b64_tr_b16 a[78:79], v123 offset:3072
    ds_read_b64_tr_b16 a[0:1], v120 offset:0
    ds_read_b64_tr_b16 a[2:3], v120 offset:1024
    ds_read_b64_tr_b16 a[4:5], v121 offset:0
    ds_read_b64_tr_b16 a[6:7], v121 offset:1024
    ds_read_b64_tr_b16 a[8:9], v120 offset:2048
    ds_read_b64_tr_b16 a[10:11], v120 offset:3072
    ds_read_b64_tr_b16 a[12:13], v121 offset:2048
    ds_read_b64_tr_b16 a[14:15], v121 offset:3072
    v_fma_f32 v192, -v88, v56, v192
    v_fma_f32 v224, -v88, v72, v224
    v_fma_f32 v193, -v88, v57, v193
    v_fma_f32 v225, -v88, v73, v225
    v_fma_f32 v194, -v88, v58, v194
    v_fma_f32 v226, -v88, v74, v226
    v_fma_f32 v195, -v88, v59, v195
    v_fma_f32 v227, -v88, v75, v227
    s_add_u32 m0, s90, 98304
    s_nop 0
    buffer_load_dwordx4 v112, s[28:31], s74 offen offset:0 lds
    v_fma_f32 v196, -v88, v60, v196
    v_fma_f32 v228, -v88, v76, v228
    v_fma_f32 v197, -v88, v61, v197
    v_fma_f32 v229, -v88, v77, v229
    v_fma_f32 v198, -v88, v62, v198
    v_fma_f32 v230, -v88, v78, v230
    v_fma_f32 v199, -v88, v63, v199
    v_fma_f32 v231, -v88, v79, v231
    buffer_load_dwordx4 v113, s[28:31], s74 offen offset:1024 lds
    v_max_f32 v192, 0, v192
    v_max_f32 v193, 0, v193
    v_max_f32 v194, 0, v194
    v_max_f32 v195, 0, v195
    v_max_f32 v196, 0, v196
    v_max_f32 v197, 0, v197
    v_max_f32 v198, 0, v198
    v_max_f32 v199, 0, v199
    buffer_load_dwordx4 v114, s[28:31], s74 offen offset:2048 lds
    v_mul_f32 v192, v192, v224
    v_mul_f32 v193, v193, v225
    v_mul_f32 v194, v194, v226
    v_mul_f32 v195, v195, v227
    v_mul_f32 v196, v196, v228
    v_mul_f32 v197, v197, v229
    v_mul_f32 v198, v198, v230
    v_mul_f32_e64 v199, v199, v231
    buffer_load_dwordx4 v115, s[28:31], s74 offen offset:3072 lds
    v_cvt_pk_bf16_f32 v96, v192, v193
    v_cvt_pk_bf16_f32 v97, v194, v195
    v_cvt_pk_bf16_f32 v98, v196, v197
    v_cvt_pk_bf16_f32 v99, v198, v199
    v_fma_f32 v200, -v88, v64, v200
    v_fma_f32 v232, -v88, v80, v232
    v_fma_f32 v201, -v88, v65, v201
    v_fma_f32 v233, -v88, v81, v233
    s_add_u32 m0, s90, 131072
    s_nop 0
    buffer_load_dwordx4 v116, s[28:31], s76 offen offset:0 lds
    v_fma_f32 v202, -v88, v66, v202
    v_fma_f32 v234, -v88, v82, v234
    v_fma_f32 v203, -v88, v67, v203
    v_fma_f32 v235, -v88, v83, v235
    s_add_u32 s92, s62, 4096
    buffer_store_dwordx4 v[96:99], v2, s[36:39], s92 offen offset:0 sc1
    v_fma_f32 v204, -v88, v68, v204
    v_fma_f32 v236, -v88, v84, v236
    buffer_load_dwordx4 v117, s[28:31], s76 offen offset:1024 lds
    v_fma_f32 v205, -v88, v69, v205
    v_fma_f32 v237, -v88, v85, v237
    v_fma_f32 v206, -v88, v70, v206
    v_fma_f32 v238, -v88, v86, v238
    v_fma_f32 v207, -v88, v71, v207
    v_fma_f32 v239, -v88, v87, v239
    v_max_f32 v200, 0, v200
    v_max_f32 v201, 0, v201
    buffer_load_dwordx4 v118, s[28:31], s76 offen offset:2048 lds
    v_max_f32 v202, 0, v202
    v_max_f32 v203, 0, v203
    v_max_f32 v204, 0, v204
    v_max_f32 v205, 0, v205
    v_max_f32 v206, 0, v206
    v_max_f32 v207, 0, v207
    v_mul_f32 v200, v200, v232
    v_mul_f32 v201, v201, v233
    buffer_load_dwordx4 v119, s[28:31], s76 offen offset:3072 lds
    v_mul_f32 v202, v202, v234
    v_mul_f32 v203, v203, v235
    v_mul_f32 v204, v204, v236
    v_mul_f32 v205, v205, v237
    v_mul_f32 v206, v206, v238
    v_mul_f32_e64 v207, v207, v239
    v_cvt_pk_bf16_f32 v100, v200, v201
    v_cvt_pk_bf16_f32 v101, v202, v203
    s_waitcnt lgkmcnt(0)
    s_add_u32 m0, s90, 114688
    s_nop 0
    buffer_load_dwordx4 v116, s[28:31], s75 offen offset:0 lds
    v_cvt_pk_bf16_f32 v102, v204, v205
    v_cvt_pk_bf16_f32 v103, v206, v207
    v_fma_f32 v208, -v89, v56, v208
    v_fma_f32 v240, -v89, v72, v240
    v_fma_f32 v209, -v89, v57, v209
    v_fma_f32 v241, -v89, v73, v241
    v_fma_f32 v210, -v89, v58, v210
    v_fma_f32 v242, -v89, v74, v242
    buffer_load_dwordx4 v117, s[28:31], s75 offen offset:1024 lds
    v_fma_f32 v211, -v89, v59, v211
    v_fma_f32 v243, -v89, v75, v243
    s_add_u32 s92, s62, 4096
    buffer_store_dwordx4 v[100:103], v2, s[36:39], s92 offen offset:1024 sc1
    v_fma_f32 v212, -v89, v60, v212
    v_fma_f32 v244, -v89, v76, v244
    v_fma_f32 v213, -v89, v61, v213
    v_fma_f32 v245, -v89, v77, v245
    buffer_load_dwordx4 v118, s[28:31], s75 offen offset:2048 lds
    v_fma_f32 v214, -v89, v62, v214
    v_fma_f32 v246, -v89, v78, v246
    v_fma_f32 v215, -v89, v63, v215
    v_fma_f32 v247, -v89, v79, v247
    v_max_f32 v208, 0, v208
    v_max_f32 v209, 0, v209
    v_max_f32 v210, 0, v210
    v_max_f32_e64 v211, 0, v211
    buffer_load_dwordx4 v119, s[28:31], s75 offen offset:3072 lds
    v_max_f32 v212, 0, v212
    v_max_f32 v213, 0, v213
    v_max_f32 v214, 0, v214
    v_max_f32 v215, 0, v215
    v_mul_f32 v208, v208, v240
    v_mul_f32 v209, v209, v241
    v_mul_f32 v210, v210, v242
    v_mul_f32_e64 v211, v211, v243
    s_add_u32 m0, s90, 49152
    s_nop 0
    buffer_load_dwordx4 v116, s[28:31], 0 offen offset:0 lds
    v_mul_f32 v212, v212, v244
    v_mul_f32 v213, v213, v245
    v_mul_f32 v214, v214, v246
    v_mul_f32 v215, v215, v247
    v_cvt_pk_bf16_f32 v104, v208, v209
    v_cvt_pk_bf16_f32 v105, v210, v211
    v_cvt_pk_bf16_f32 v106, v212, v213
    v_cvt_pk_bf16_f32 v107, v214, v215
    buffer_load_dwordx4 v117, s[28:31], 0 offen offset:1024 lds
    v_fma_f32 v216, -v89, v64, v216
    v_fma_f32 v248, -v89, v80, v248
    v_fma_f32 v217, -v89, v65, v217
    v_fma_f32 v249, -v89, v81, v249
    v_fma_f32 v218, -v89, v66, v218
    v_fma_f32 v250, -v89, v82, v250
    v_fma_f32 v219, -v89, v67, v219
    v_fma_f32 v251, -v89, v83, v251
    buffer_load_dwordx4 v118, s[28:31], 0 offen offset:2048 lds
    s_add_u32 s92, s63, 4096
    buffer_store_dwordx4 v[104:107], v2, s[36:39], s92 offen offset:0 sc1
    v_fma_f32 v220, -v89, v68, v220
    v_fma_f32 v252, -v89, v84, v252
    v_fma_f32 v221, -v89, v69, v221
    v_fma_f32 v253, -v89, v85, v253
    v_fma_f32 v222, -v89, v70, v222
    v_fma_f32 v254, -v89, v86, v254
    buffer_load_dwordx4 v119, s[28:31], 0 offen offset:3072 lds
    v_fma_f32 v223, -v89, v71, v223
    v_fma_f32 v255, -v89, v87, v255
    v_max_f32 v216, 0, v216
    v_max_f32 v217, 0, v217
    v_max_f32 v218, 0, v218
    v_max_f32 v219, 0, v219
    v_max_f32 v220, 0, v220
    v_max_f32 v221, 0, v221
    v_max_f32 v222, 0, v222
    v_max_f32 v223, 0, v223
    v_mul_f32 v216, v216, v248
    v_mul_f32 v217, v217, v249
    v_mul_f32 v218, v218, v250
    v_mul_f32 v219, v219, v251
    v_mul_f32 v220, v220, v252
    v_mul_f32 v221, v221, v253
    v_mul_f32 v222, v222, v254
    v_mul_f32_e64 v223, v223, v255
    v_cvt_pk_bf16_f32 v108, v216, v217
    v_cvt_pk_bf16_f32 v109, v218, v219
    v_cvt_pk_bf16_f32 v110, v220, v221
    v_cvt_pk_bf16_f32 v111, v222, v223
    s_add_u32 s92, s63, 4096
    buffer_store_dwordx4 v[108:111], v2, s[36:39], s92 offen offset:1024 sc1
    s_lshr_b32 s92, s83, 1
    s_lshl_b32 s92, s92, 3
    s_lshl_b32 s93, s79, 1
    s_add_u32 s92, s92, s93
    s_and_b32 s93, s83, 1
    s_add_u32 s92, s92, s93
    s_lshl_b32 s92, s92, 6
    s_add_u32 s101, s92, 4096
    v_min_u32 v94, 13, v1
    v_lshlrev_b32_e64 v94, 2, v94
    s_waitcnt vmcnt(21)
    s_barrier
    ds_read_b64 v[56:57], v17 offset:3584
    ds_read_b64 v[58:59], v17 offset:3592
    ds_read_b128 v[160:163], v16 offset:3584
    ds_read_b64 v[60:61], v17 offset:3072
    ds_read_b64 v[62:63], v17 offset:3080
    ds_read_b128 v[164:167], v16 offset:3072
    ds_read_b64 v[64:65], v17 offset:2560
    ds_read_b64 v[66:67], v17 offset:2568
    s_waitcnt lgkmcnt(5)
    v_mfma_f32_16x16x32_bf16 v[156:159], v[56:59], v[160:163], 0
    ds_read_b128 v[168:171], v16 offset:2560
    ds_read_b64 v[68:69], v17 offset:2048
    ds_read_b64 v[70:71], v17 offset:2056
    s_waitcnt lgkmcnt(6)
    v_mfma_f32_16x16x32_bf16 v[152:155], v[60:63], v[160:163], 0
    ds_read_b128 v[172:175], v16 offset:2048
    s_add_u32 m0, s90, 147456
    s_waitcnt lgkmcnt(6)
    v_mfma_f32_16x16x32_bf16 v[156:159], v[60:63], v[164:167], v[156:159]
    ds_read_b64 v[56:57], v17 offset:1536
    ds_read_b64 v[58:59], v17 offset:1544
    s_waitcnt lgkmcnt(6)
    v_mfma_f32_16x16x32_bf16 v[148:151], v[64:67], v[160:163], 0
    ds_read_b128 v[176:179], v16 offset:1536
    buffer_load_dwordx4 v112, s[28:31], s77 offen offset:0 lds
    v_mfma_f32_16x16x32_bf16 v[152:155], v[64:67], v[164:167], v[152:155]
    ds_read_b64 v[60:61], v17 offset:1024
    ds_read_b64_tr_b16 a[16:17], v120 offset:16384
    s_waitcnt lgkmcnt(8)
    v_mfma_f32_16x16x32_bf16 v[156:159], v[64:67], v[168:171], v[156:159]
    ds_read_b64 v[62:63], v17 offset:1032
    ds_read_b64_tr_b16 a[18:19], v120 offset:17408
    s_waitcnt lgkmcnt(8)
    v_mfma_f32_16x16x32_bf16 v[144:147], v[68:71], v[160:163], 0
    ds_read_b128 v[180:183], v16 offset:1024
    ds_read_b64_tr_b16 a[20:21], v121 offset:16384
    v_mfma_f32_16x16x32_bf16 v[148:151], v[68:71], v[164:167], v[148:151]
    ds_read_b64 v[64:65], v17 offset:512
    buffer_load_dwordx4 v113, s[28:31], s77 offen offset:1024 lds
    v_mfma_f32_16x16x32_bf16 v[152:155], v[68:71], v[168:171], v[152:155]
    ds_read_b64 v[66:67], v17 offset:520
    ds_read_b64_tr_b16 a[22:23], v121 offset:17408
    s_waitcnt lgkmcnt(12)
    v_mfma_f32_16x16x32_bf16 v[156:159], v[68:71], v[172:175], v[156:159]
    ds_read_b64_tr_b16 a[24:25], v120 offset:18432
    ds_read_b64_tr_b16 a[26:27], v120 offset:19456
    s_waitcnt lgkmcnt(12)
    v_mfma_f32_16x16x32_bf16 v[140:143], v[56:59], v[160:163], 0
    ds_read_b128 v[184:187], v16 offset:512
    ds_read_b64_tr_b16 a[28:29], v121 offset:18432
    v_mfma_f32_16x16x32_bf16 v[144:147], v[56:59], v[164:167], v[144:147]
    ds_read_b64 v[68:69], v17 offset:0
    buffer_load_dwordx4 v114, s[28:31], s77 offen offset:2048 lds
    v_mfma_f32_16x16x32_bf16 v[148:151], v[56:59], v[168:171], v[148:151]
    ds_read_b64 v[70:71], v17 offset:8
    ds_read_b64_tr_b16 a[30:31], v121 offset:19456
    v_mfma_f32_16x16x32_bf16 v[152:155], v[56:59], v[172:175], v[152:155]
    ds_read_b64_tr_b16 a[32:33], v120 offset:32768
    v_mfma_f32_16x16x32_bf16 v[156:159], v[56:59], v[176:179], v[156:159]
    ds_read_b64_tr_b16 a[34:35], v120 offset:33792
    ds_read_b64_tr_b16 a[36:37], v121 offset:32768
    v_mfma_f32_16x16x32_bf16 v[136:139], v[60:63], v[160:163], 0
    ds_read_b128 v[188:191], v16 offset:0
    buffer_load_dwordx4 v115, s[28:31], s77 offen offset:3072 lds
    v_mfma_f32_16x16x32_bf16 v[140:143], v[60:63], v[164:167], v[140:143]
    ds_read_b64 v[56:57], v17 offset:3648
    ds_read_b64_tr_b16 a[38:39], v121 offset:33792
    v_mfma_f32_16x16x32_bf16 v[144:147], v[60:63], v[168:171], v[144:147]
    ds_read_b64 v[58:59], v17 offset:3656
    ds_read_b64_tr_b16 a[40:41], v120 offset:34816
    v_mfma_f32_16x16x32_bf16 v[148:151], v[60:63], v[172:175], v[148:151]
    ds_read_b64_tr_b16 a[42:43], v120 offset:35840
    ds_read_b64_tr_b16 a[44:45], v121 offset:34816
    v_mfma_f32_16x16x32_bf16 v[152:155], v[60:63], v[176:179], v[152:155]
    ds_read_b64_tr_b16 a[46:47], v121 offset:35840
    s_waitcnt vmcnt(20)
    ds_read_b64_tr_b16 a[48:49], v120 offset:49152
    v_mfma_f32_16x16x32_bf16 v[156:159], v[60:63], v[180:183], v[156:159]
    s_waitcnt lgkmcnt(12)
    s_add_u32 m0, s90, 65536
    v_mfma_f32_16x16x32_bf16 v[132:135], v[64:67], v[160:163], 0
    ds_read_b64 v[60:61], v17 offset:3136
    buffer_load_dwordx4 v116, s[28:31], s72 offen offset:0 lds
    v_mfma_f32_16x16x32_bf16 v[136:139], v[64:67], v[164:167], v[136:139]
    ds_read_b64 v[62:63], v17 offset:3144
    ds_read_b64_tr_b16 a[50:51], v120 offset:50176
    v_mfma_f32_16x16x32_bf16 v[140:143], v[64:67], v[168:171], v[140:143]
    ds_read_b64_tr_b16 a[52:53], v121 offset:49152
    ds_read_b64_tr_b16 a[54:55], v121 offset:50176
    v_mfma_f32_16x16x32_bf16 v[144:147], v[64:67], v[172:175], v[144:147]
    ds_read_b64_tr_b16 a[56:57], v120 offset:51200
    ds_read_b64_tr_b16 a[58:59], v120 offset:52224
    v_mfma_f32_16x16x32_bf16 v[148:151], v[64:67], v[176:179], v[148:151]
    buffer_load_dwordx4 v117, s[28:31], s72 offen offset:1024 lds
    ds_read_b64_tr_b16 a[60:61], v121 offset:51200
    v_mfma_f32_16x16x32_bf16 v[152:155], v[64:67], v[180:183], v[152:155]
    ds_read_b64_tr_b16 a[62:63], v121 offset:52224
    v_mfma_f32_16x16x32_bf16 v[156:159], v[64:67], v[184:187], v[156:159]
    v_mfma_f32_16x16x32_bf16 v[128:131], v[68:71], v[160:163], 0
    ds_read_b128 v[160:163], v16 offset:3648
    v_mfma_f32_16x16x32_bf16 v[132:135], v[68:71], v[164:167], v[132:135]
    ds_read_b128 v[164:167], v16 offset:3136
    buffer_load_dwordx4 v118, s[28:31], s72 offen offset:2048 lds
    v_mfma_f32_16x16x32_bf16 v[136:139], v[68:71], v[168:171], v[136:139]
    ds_read_b64 v[64:65], v17 offset:2624
    v_mfma_f32_16x16x32_bf16 v[140:143], v[68:71], v[172:175], v[140:143]
    ds_read_b64 v[66:67], v17 offset:2632
    v_mfma_f32_16x16x32_bf16 v[144:147], v[68:71], v[176:179], v[144:147]
    v_mfma_f32_16x16x32_bf16 v[148:151], v[68:71], v[180:183], v[148:151]
    buffer_load_dwordx4 v119, s[28:31], s72 offen offset:3072 lds
    s_waitcnt lgkmcnt(9)
    s_add_u32 m0, s90, 81920
    v_mfma_f32_16x16x32_bf16 v[152:155], v[68:71], v[184:187], v[152:155]
    v_mfma_f32_16x16x32_bf16 v[156:159], v[68:71], v[188:191], v[156:159]
    s_waitcnt lgkmcnt(3)
    v_mfma_f32_16x16x32_bf16 v[156:159], v[56:59], v[160:163], v[156:159]
    ds_read_b128 v[168:171], v16 offset:2624
    ds_read_b64 v[68:69], v17 offset:2112
    ds_read_b64 v[70:71], v17 offset:2120
    v_mfma_f32_16x16x32_bf16 v[152:155], v[60:63], v[160:163], v[152:155]
    ds_read_b128 v[172:175], v16 offset:2112
    buffer_load_dwordx4 v116, s[28:31], s73 offen offset:0 lds
    s_waitcnt lgkmcnt(6)
    v_mfma_f32_16x16x32_bf16 v[156:159], v[60:63], v[164:167], v[156:159]
    ds_read_b64 v[56:57], v17 offset:1600
    ds_read_b64 v[58:59], v17 offset:1608
    s_waitcnt lgkmcnt(6)
    v_mfma_f32_16x16x32_bf16 v[148:151], v[64:67], v[160:163], v[148:151]
    ds_read_b128 v[176:179], v16 offset:1600
    v_mfma_f32_16x16x32_bf16 v[152:155], v[64:67], v[164:167], v[152:155]
    ds_read_b64 v[60:61], v17 offset:1088
    s_waitcnt lgkmcnt(7)
    v_mfma_f32_16x16x32_bf16 v[156:159], v[64:67], v[168:171], v[156:159]
    ds_read_b64 v[62:63], v17 offset:1096
    buffer_load_dwordx4 v117, s[28:31], s73 offen offset:1024 lds
    s_waitcnt lgkmcnt(6)
    v_mfma_f32_16x16x32_bf16 v[144:147], v[68:71], v[160:163], v[144:147]
    ds_read_b128 v[180:183], v16 offset:1088
    v_mfma_f32_16x16x32_bf16 v[148:151], v[68:71], v[164:167], v[148:151]
    ds_read_b64 v[64:65], v17 offset:576
    v_mfma_f32_16x16x32_bf16 v[152:155], v[68:71], v[168:171], v[152:155]
    ds_read_b64 v[66:67], v17 offset:584
    s_waitcnt lgkmcnt(8)
    v_mfma_f32_16x16x32_bf16 v[156:159], v[68:71], v[172:175], v[156:159]
    buffer_load_dwordx4 v118, s[28:31], s73 offen offset:2048 lds
    s_waitcnt lgkmcnt(6)
    v_mfma_f32_16x16x32_bf16 v[140:143], v[56:59], v[160:163], v[140:143]
    ds_read_b128 v[184:187], v16 offset:576
    v_mfma_f32_16x16x32_bf16 v[144:147], v[56:59], v[164:167], v[144:147]
    ds_read_b64 v[68:69], v17 offset:64
    v_mfma_f32_16x16x32_bf16 v[148:151], v[56:59], v[168:171], v[148:151]
    ds_read_b64 v[70:71], v17 offset:72
    v_mfma_f32_16x16x32_bf16 v[152:155], v[56:59], v[172:175], v[152:155]
    buffer_load_dwordx4 v119, s[28:31], s73 offen offset:3072 lds
    s_add_u32 m0, s90, 98304
    s_waitcnt lgkmcnt(8)
    v_mfma_f32_16x16x32_bf16 v[156:159], v[56:59], v[176:179], v[156:159]
    s_waitcnt lgkmcnt(6)
    v_mfma_f32_16x16x32_bf16 v[136:139], v[60:63], v[160:163], v[136:139]
    ds_read_b128 v[188:191], v16 offset:64
    v_mfma_f32_16x16x32_bf16 v[140:143], v[60:63], v[164:167], v[140:143]
    ds_read_b64 v[56:57], v17 offset:3712
    v_mfma_f32_16x16x32_bf16 v[144:147], v[60:63], v[168:171], v[144:147]
    ds_read_b64 v[58:59], v17 offset:3720
    buffer_load_dwordx4 v116, s[28:31], s74 offen offset:0 lds
    v_mfma_f32_16x16x32_bf16 v[148:151], v[60:63], v[172:175], v[148:151]
    v_mfma_f32_16x16x32_bf16 v[152:155], v[60:63], v[176:179], v[152:155]
    s_waitcnt lgkmcnt(7)
    v_mfma_f32_16x16x32_bf16 v[156:159], v[60:63], v[180:183], v[156:159]
    s_waitcnt lgkmcnt(6)
    v_mfma_f32_16x16x32_bf16 v[132:135], v[64:67], v[160:163], v[132:135]
    ds_read_b64 v[60:61], v17 offset:3200
    buffer_load_dwordx4 v117, s[28:31], s74 offen offset:1024 lds
    v_mfma_f32_16x16x32_bf16 v[136:139], v[64:67], v[164:167], v[136:139]
    ds_read_b64 v[62:63], v17 offset:3208
    v_mfma_f32_16x16x32_bf16 v[140:143], v[64:67], v[168:171], v[140:143]
    s_waitcnt vmcnt(10)
    ds_read_b64_tr_b16 a[96:97], v122 offset:32768
    v_mfma_f32_16x16x32_bf16 v[144:147], v[64:67], v[172:175], v[144:147]
    ds_read_b64_tr_b16 a[98:99], v122 offset:33792
    ds_read_b64_tr_b16 a[100:101], v123 offset:32768
    v_mfma_f32_16x16x32_bf16 v[148:151], v[64:67], v[176:179], v[148:151]
    buffer_load_dwordx4 v118, s[28:31], s74 offen offset:2048 lds
    ds_read_b64_tr_b16 a[102:103], v123 offset:33792
    v_mfma_f32_16x16x32_bf16 v[152:155], v[64:67], v[180:183], v[152:155]
    ds_read_b64_tr_b16 a[104:105], v122 offset:34816
    ds_read_b64_tr_b16 a[106:107], v122 offset:35840
    s_waitcnt lgkmcnt(9)
    v_mfma_f32_16x16x32_bf16 v[156:159], v[64:67], v[184:187], v[156:159]
    ds_read_b64_tr_b16 a[108:109], v123 offset:34816
    ds_read_b64_tr_b16 a[110:111], v123 offset:35840
    v_mfma_f32_16x16x32_bf16 v[128:131], v[68:71], v[160:163], v[128:131]
    ds_read_b128 v[160:163], v16 offset:3712
    v_mfma_f32_16x16x32_bf16 v[132:135], v[68:71], v[164:167], v[132:135]
    ds_read_b128 v[164:167], v16 offset:3200
    buffer_load_dwordx4 v119, s[28:31], s74 offen offset:3072 lds
    v_mfma_f32_16x16x32_bf16 v[136:139], v[68:71], v[168:171], v[136:139]
    ds_read_b64 v[64:65], v17 offset:2688
    v_mfma_f32_16x16x32_bf16 v[140:143], v[68:71], v[172:175], v[140:143]
    ds_read_b64 v[66:67], v17 offset:2696
    v_mfma_f32_16x16x32_bf16 v[144:147], v[68:71], v[176:179], v[144:147]
    v_mfma_f32_16x16x32_bf16 v[148:151], v[68:71], v[180:183], v[148:151]
    buffer_load_dword v92, v94, s[36:39], s101 offen sc1
    v_mfma_f32_16x16x32_bf16 v[152:155], v[68:71], v[184:187], v[152:155]
    v_mfma_f32_16x16x32_bf16 v[156:159], v[68:71], v[188:191], v[156:159]
    s_waitcnt lgkmcnt(4)
    s_add_u32 m0, s90, 147456
    s_waitcnt lgkmcnt(3)
    v_mfma_f32_16x16x32_bf16 v[156:159], v[56:59], v[160:163], v[156:159]
    ds_read_b128 v[168:171], v16 offset:2688
    ds_read_b64 v[68:69], v17 offset:2176
    ds_read_b64 v[70:71], v17 offset:2184
    v_mfma_f32_16x16x32_bf16 v[152:155], v[60:63], v[160:163], v[152:155]
    ds_read_b128 v[172:175], v16 offset:2176
    buffer_load_dwordx4 v116, s[28:31], s77 offen offset:0 lds
    s_waitcnt lgkmcnt(6)
    v_mfma_f32_16x16x32_bf16 v[156:159], v[60:63], v[164:167], v[156:159]
    ds_read_b64 v[56:57], v17 offset:1664
    ds_read_b64 v[58:59], v17 offset:1672
    s_waitcnt lgkmcnt(6)
    v_mfma_f32_16x16x32_bf16 v[148:151], v[64:67], v[160:163], v[148:151]
    ds_read_b128 v[176:179], v16 offset:1664
    v_mfma_f32_16x16x32_bf16 v[152:155], v[64:67], v[164:167], v[152:155]
    ds_read_b64 v[60:61], v17 offset:1152
    s_waitcnt lgkmcnt(7)
    v_mfma_f32_16x16x32_bf16 v[156:159], v[64:67], v[168:171], v[156:159]
    ds_read_b64 v[62:63], v17 offset:1160
    buffer_load_dwordx4 v117, s[28:31], s77 offen offset:1024 lds
    s_waitcnt lgkmcnt(6)
    v_mfma_f32_16x16x32_bf16 v[144:147], v[68:71], v[160:163], v[144:147]
    ds_read_b128 v[180:183], v16 offset:1152
    v_mfma_f32_16x16x32_bf16 v[148:151], v[68:71], v[164:167], v[148:151]
    ds_read_b64 v[64:65], v17 offset:640
    v_mfma_f32_16x16x32_bf16 v[152:155], v[68:71], v[168:171], v[152:155]
    ds_read_b64 v[66:67], v17 offset:648
    s_waitcnt lgkmcnt(8)
    v_mfma_f32_16x16x32_bf16 v[156:159], v[68:71], v[172:175], v[156:159]
    buffer_load_dwordx4 v118, s[28:31], s77 offen offset:2048 lds
    s_waitcnt lgkmcnt(6)
    v_mfma_f32_16x16x32_bf16 v[140:143], v[56:59], v[160:163], v[140:143]
    ds_read_b128 v[184:187], v16 offset:640
    v_mfma_f32_16x16x32_bf16 v[144:147], v[56:59], v[164:167], v[144:147]
    ds_read_b64 v[68:69], v17 offset:128
    v_mfma_f32_16x16x32_bf16 v[148:151], v[56:59], v[168:171], v[148:151]
    ds_read_b64 v[70:71], v17 offset:136
    v_mfma_f32_16x16x32_bf16 v[152:155], v[56:59], v[172:175], v[152:155]
    buffer_load_dwordx4 v119, s[28:31], s77 offen offset:3072 lds
    s_lshl_b32 s92, s81, 3
    s_waitcnt lgkmcnt(8)
    v_mfma_f32_16x16x32_bf16 v[156:159], v[56:59], v[176:179], v[156:159]
    s_add_u32 s92, s92, s78
    s_lshl_b32 s92, s92, 6
    s_waitcnt lgkmcnt(6)
    v_mfma_f32_16x16x32_bf16 v[136:139], v[60:63], v[160:163], v[136:139]
    ds_read_b128 v[188:191], v16 offset:128
    s_lshl_b32 s93, s82, 2
    v_mfma_f32_16x16x32_bf16 v[140:143], v[60:63], v[164:167], v[140:143]
    ds_read_b64 v[56:57], v17 offset:3776
    s_add_u32 s92, s92, s93
    v_mfma_f32_16x16x32_bf16 v[144:147], v[60:63], v[168:171], v[144:147]
    ds_read_b64 v[58:59], v17 offset:3784
    s_add_u32 s92, s92, 4352
    v_mfma_f32_16x16x32_bf16 v[148:151], v[60:63], v[172:175], v[148:151]
    v_mov_b32_e64 v5, s85
    v_mfma_f32_16x16x32_bf16 v[152:155], v[60:63], v[176:179], v[152:155]
    buffer_store_dword v5, v3, s[36:39], s92 offen sc1
    s_waitcnt lgkmcnt(5)
    v_mfma_f32_16x16x32_bf16 v[156:159], v[60:63], v[180:183], v[156:159]
    v_mfma_f32_16x16x32_bf16 v[132:135], v[64:67], v[160:163], v[132:135]
    ds_read_b64 v[60:61], v17 offset:3264
    v_mfma_f32_16x16x32_bf16 v[136:139], v[64:67], v[164:167], v[136:139]
    ds_read_b64 v[62:63], v17 offset:3272
    v_mfma_f32_16x16x32_bf16 v[140:143], v[64:67], v[168:171], v[140:143]
    v_mfma_f32_16x16x32_bf16 v[144:147], v[64:67], v[172:175], v[144:147]
    v_mfma_f32_16x16x32_bf16 v[148:151], v[64:67], v[176:179], v[148:151]
    v_mfma_f32_16x16x32_bf16 v[152:155], v[64:67], v[180:183], v[152:155]
    v_mfma_f32_16x16x32_bf16 v[156:159], v[64:67], v[184:187], v[156:159]
    s_waitcnt lgkmcnt(5)
    v_mfma_f32_16x16x32_bf16 v[128:131], v[68:71], v[160:163], v[128:131]
    ds_read_b128 v[160:163], v16 offset:3776
    v_mfma_f32_16x16x32_bf16 v[132:135], v[68:71], v[164:167], v[132:135]
    ds_read_b128 v[164:167], v16 offset:3264
    v_mfma_f32_16x16x32_bf16 v[136:139], v[68:71], v[168:171], v[136:139]
    ds_read_b64 v[64:65], v17 offset:2752
    v_mfma_f32_16x16x32_bf16 v[140:143], v[68:71], v[172:175], v[140:143]
    ds_read_b64 v[66:67], v17 offset:2760
    v_mfma_f32_16x16x32_bf16 v[144:147], v[68:71], v[176:179], v[144:147]
    v_mfma_f32_16x16x32_bf16 v[148:151], v[68:71], v[180:183], v[148:151]
    v_mfma_f32_16x16x32_bf16 v[152:155], v[68:71], v[184:187], v[152:155]
    s_waitcnt lgkmcnt(6)
    v_mfma_f32_16x16x32_bf16 v[156:159], v[68:71], v[188:191], v[156:159]
    s_waitcnt lgkmcnt(3)
    v_mfma_f32_16x16x32_bf16 v[156:159], v[56:59], v[160:163], v[156:159]
    ds_read_b128 v[168:171], v16 offset:2752
    ds_read_b64 v[68:69], v17 offset:2240
    ds_read_b64 v[70:71], v17 offset:2248
    v_mfma_f32_16x16x32_bf16 v[152:155], v[60:63], v[160:163], v[152:155]
    ds_read_b128 v[172:175], v16 offset:2240
    s_waitcnt lgkmcnt(6)
    v_mfma_f32_16x16x32_bf16 v[156:159], v[60:63], v[164:167], v[156:159]
    ds_read_b64 v[56:57], v17 offset:1728
    ds_read_b64 v[58:59], v17 offset:1736
    s_waitcnt lgkmcnt(6)
    v_mfma_f32_16x16x32_bf16 v[148:151], v[64:67], v[160:163], v[148:151]
    ds_read_b128 v[176:179], v16 offset:1728
    v_mfma_f32_16x16x32_bf16 v[152:155], v[64:67], v[164:167], v[152:155]
    ds_read_b64 v[60:61], v17 offset:1216
    s_waitcnt lgkmcnt(7)
    v_mfma_f32_16x16x32_bf16 v[156:159], v[64:67], v[168:171], v[156:159]
    ds_read_b64 v[62:63], v17 offset:1224
    s_waitcnt vmcnt(5)
    v_cmp_ne_u32 vcc, s85, v92
    s_nop 3
    s_cmp_lg_u64 vcc, 0
    s_cbranch_scc1 L_slow_h0
L_back_h0:
    buffer_load_dwordx4 a[112:115], v124, s[36:39], 0 offen offset:0 sc1
    s_waitcnt lgkmcnt(6)
    v_mfma_f32_16x16x32_bf16 v[144:147], v[68:71], v[160:163], v[144:147]
    ds_read_b128 v[180:183], v16 offset:1216
    v_mfma_f32_16x16x32_bf16 v[148:151], v[68:71], v[164:167], v[148:151]
    ds_read_b64 v[64:65], v17 offset:704
    v_mfma_f32_16x16x32_bf16 v[152:155], v[68:71], v[168:171], v[152:155]
    ds_read_b64 v[66:67], v17 offset:712
    s_waitcnt lgkmcnt(8)
    v_mfma_f32_16x16x32_bf16 v[156:159], v[68:71], v[172:175], v[156:159]
    buffer_load_dwordx4 a[116:119], v125, s[36:39], 0 offen offset:0 sc1
    s_waitcnt lgkmcnt(6)
    v_mfma_f32_16x16x32_bf16 v[140:143], v[56:59], v[160:163], v[140:143]
    ds_read_b128 v[184:187], v16 offset:704
    v_mfma_f32_16x16x32_bf16 v[144:147], v[56:59], v[164:167], v[144:147]
    ds_read_b64 v[68:69], v17 offset:192
    v_mfma_f32_16x16x32_bf16 v[148:151], v[56:59], v[168:171], v[148:151]
    ds_read_b64 v[70:71], v17 offset:200
    v_mfma_f32_16x16x32_bf16 v[152:155], v[56:59], v[172:175], v[152:155]
    buffer_load_dwordx4 a[120:123], v124, s[36:39], 0 offen offset:1024 sc1
    s_waitcnt lgkmcnt(7)
    v_mfma_f32_16x16x32_bf16 v[156:159], v[56:59], v[176:179], v[156:159]
    s_waitcnt lgkmcnt(6)
    v_mfma_f32_16x16x32_bf16 v[136:139], v[60:63], v[160:163], v[136:139]
    ds_read_b128 v[188:191], v16 offset:192
    v_mfma_f32_16x16x32_bf16 v[140:143], v[60:63], v[164:167], v[140:143]
    v_mfma_f32_16x16x32_bf16 v[144:147], v[60:63], v[168:171], v[144:147]
    buffer_load_dwordx4 a[124:127], v125, s[36:39], 0 offen offset:1024 sc1
    v_mfma_f32_16x16x32_bf16 v[148:151], v[60:63], v[172:175], v[148:151]
    v_mfma_f32_16x16x32_bf16 v[152:155], v[60:63], v[176:179], v[152:155]
    s_waitcnt lgkmcnt(6)
    v_mfma_f32_16x16x32_bf16 v[156:159], v[60:63], v[180:183], v[156:159]
    s_waitcnt lgkmcnt(4)
    v_mfma_f32_16x16x32_bf16 v[132:135], v[64:67], v[160:163], v[132:135]
    buffer_load_dwordx4 a[128:131], v124, s[36:39], s65 offen offset:0 sc1
    v_mfma_f32_16x16x32_bf16 v[136:139], v[64:67], v[164:167], v[136:139]
    v_mfma_f32_16x16x32_bf16 v[140:143], v[64:67], v[168:171], v[140:143]
    v_mfma_f32_16x16x32_bf16 v[144:147], v[64:67], v[172:175], v[144:147]
    v_mfma_f32_16x16x32_bf16 v[148:151], v[64:67], v[176:179], v[148:151]
    buffer_load_dwordx4 a[132:135], v125, s[36:39], s65 offen offset:0 sc1
    v_mfma_f32_16x16x32_bf16 v[152:155], v[64:67], v[180:183], v[152:155]
    s_waitcnt lgkmcnt(3)
    v_mfma_f32_16x16x32_bf16 v[156:159], v[64:67], v[184:187], v[156:159]
    s_waitcnt lgkmcnt(1)
    v_mfma_f32_16x16x32_bf16 v[128:131], v[68:71], v[160:163], v[128:131]
    v_mfma_f32_16x16x32_bf16 v[132:135], v[68:71], v[164:167], v[132:135]
    buffer_load_dwordx4 a[136:139], v124, s[36:39], s65 offen offset:1024 sc1
    v_mfma_f32_16x16x32_bf16 v[136:139], v[68:71], v[168:171], v[136:139]
    v_mfma_f32_16x16x32_bf16 v[140:143], v[68:71], v[172:175], v[140:143]
    v_mfma_f32_16x16x32_bf16 v[144:147], v[68:71], v[176:179], v[144:147]
    v_mfma_f32_16x16x32_bf16 v[148:151], v[68:71], v[180:183], v[148:151]
    buffer_load_dwordx4 a[140:143], v125, s[36:39], s65 offen offset:1024 sc1
    v_mfma_f32_16x16x32_bf16 v[152:155], v[68:71], v[184:187], v[152:155]
    s_waitcnt lgkmcnt(0)
    v_mfma_f32_16x16x32_bf16 v[156:159], v[68:71], v[188:191], v[156:159]
    v_mov_b32 v89, v95
    s_waitcnt lgkmcnt(0)
    s_barrier
    s_xor_b32 s86, s78, 1
    s_lshl_b32 s86, s86, 12
    v_add_u32 v4, s86, v2
    v_add_u32 v5, s90, v2
    v_lshlrev_b32_e64 v89, 16, v89
    s_nop 2
    s_cmp_eq_u32 s79, 0
    s_cbranch_scc1 L_cv_lo
    ds_write_b128 v4, v[128:131] offset:0
    ds_write_b128 v4, v[132:135] offset:1024
    ds_write_b128 v4, v[136:139] offset:2048
    ds_write_b128 v4, v[140:143] offset:3072
    v_mov_b32 v160, v144
    v_mov_b32 v161, v145
    v_mov_b32 v162, v146
    v_mov_b32 v163, v147
    v_mov_b32 v164, v148
    v_mov_b32 v165, v149
    v_mov_b32 v166, v150
    v_mov_b32 v167, v151
    v_mov_b32 v168, v152
    v_mov_b32 v169, v153
    v_mov_b32 v170, v154
    v_mov_b32 v171, v155
    v_mov_b32 v172, v156
    v_mov_b32 v173, v157
    v_mov_b32 v174, v158
    v_mov_b32_e64 v175, v159
    s_branch L_cv_join
L_cv_lo:
    ds_write_b128 v4, v[144:147] offset:0
    ds_write_b128 v4, v[148:151] offset:1024
    ds_write_b128 v4, v[152:155] offset:2048
    ds_write_b128 v4, v[156:159] offset:3072
    v_mov_b32 v160, v128
    v_mov_b32 v161, v129
    v_mov_b32 v162, v130
    v_mov_b32 v163, v131
    v_mov_b32 v164, v132
    v_mov_b32 v165, v133
    v_mov_b32 v166, v134
    v_mov_b32 v167, v135
    v_mov_b32 v168, v136
    v_mov_b32 v169, v137
    v_mov_b32 v170, v138
    v_mov_b32 v171, v139
    v_mov_b32 v172, v140
    v_mov_b32 v173, v141
    v_mov_b32 v174, v142
    v_mov_b32_e64 v175, v143
L_cv_join:
    ds_read_b64 v[56:57], v26 offset:1536
    ds_read_b64 v[58:59], v26 offset:1024
    ds_read_b64 v[60:61], v26 offset:512
    ds_read_b64 v[62:63], v26 offset:0
    s_waitcnt lgkmcnt(0)
    buffer_load_dwordx4 a[144:147], v124, s[36:39], s66 offen offset:0 sc1
    s_barrier
    ds_read_b128 v[176:179], v5 offset:0
    ds_read_b128 v[180:183], v5 offset:1024
    ds_read_b128 v[184:187], v5 offset:2048
    ds_read_b128 v[188:191], v5 offset:3072
    buffer_load_dwordx4 a[148:151], v125, s[36:39], s66 offen offset:0 sc1
    s_lshl_b32 s86, s2, 1
    s_add_u32 s86, s86, s80
    s_lshl_b32 s86, s86, 13
    s_lshl_b32 s88, s79, 12
    s_add_u32 s86, s86, s88
    buffer_load_dwordx4 a[152:155], v124, s[36:39], s66 offen offset:1024 sc1
    s_add_u32 s86, s86, 3145728
    v_lshlrev_b32 v27, 1, v27
    v_mov_b32 v65, s85
    v_mov_b32 v67, s85
    v_mov_b32 v69, s85
    buffer_load_dwordx4 a[156:159], v125, s[36:39], s66 offen offset:1024 sc1
    v_mov_b32 v71, s85
    v_mov_b32 v73, s85
    v_mov_b32 v75, s85
    v_mov_b32 v77, s85
    v_mov_b32_e64 v79, s85
    buffer_load_dwordx4 a[160:163], v124, s[36:39], s67 offen offset:0 sc1
    v_and_b32 v8, s3, v57
    v_lshlrev_b32 v9, 16, v57
    v_and_b32 v10, s3, v56
    v_lshlrev_b32 v11, 16, v56
    v_fmac_f32_e64 v160, v89, v8
    buffer_load_dwordx4 a[164:167], v125, s[36:39], s67 offen offset:0 sc1
    v_fmac_f32 v161, v89, v9
    v_fmac_f32 v162, v89, v10
    v_fmac_f32 v163, v89, v11
    s_waitcnt lgkmcnt(0)
    v_add_f32 v160, v160, v176
    v_add_f32 v161, v161, v177
    buffer_load_dwordx4 a[168:171], v124, s[36:39], s67 offen offset:1024 sc1
    v_add_f32 v162, v162, v178
    v_add_f32 v163, v163, v179
    v_cvt_pk_bf16_f32 v64, v160, v161
    v_cvt_pk_bf16_f32 v66, v162, v163
    v_and_b32_e64 v8, s3, v59
    buffer_load_dwordx4 a[172:175], v125, s[36:39], s67 offen offset:1024 sc1
    v_lshlrev_b32 v9, 16, v59
    v_and_b32 v10, s3, v58
    v_lshlrev_b32 v11, 16, v58
    v_fmac_f32 v164, v89, v8
    v_fmac_f32_e64 v165, v89, v9
    buffer_load_dwordx4 a[176:179], v124, s[36:39], s68 offen offset:0 sc1
    v_fmac_f32 v166, v89, v10
    v_fmac_f32 v167, v89, v11
    v_add_f32 v164, v164, v180
    v_add_f32 v165, v165, v181
    v_add_f32_e64 v166, v166, v182
    buffer_load_dwordx4 a[180:183], v125, s[36:39], s68 offen offset:0 sc1
    v_add_f32_e64 v167, v167, v183
    buffer_store_dwordx4 v[64:67], v27, s[36:39], s86 offen offset:0 sc1
    v_cvt_pk_bf16_f32 v68, v164, v165
    v_cvt_pk_bf16_f32 v70, v166, v167
    v_and_b32 v8, s3, v61
    v_lshlrev_b32 v9, 16, v61
    v_and_b32 v10, s3, v60
    v_lshlrev_b32 v11, 16, v60
    v_fmac_f32 v168, v89, v8
    v_fmac_f32 v169, v89, v9
    v_fmac_f32 v170, v89, v10
    v_fmac_f32 v171, v89, v11
    v_add_f32 v168, v168, v184
    v_add_f32 v169, v169, v185
    v_add_f32 v170, v170, v186
    v_add_f32 v171, v171, v187
    buffer_store_dwordx4 v[68:71], v27, s[36:39], s86 offen offset:1024 sc1
    v_cvt_pk_bf16_f32 v72, v168, v169
    v_cvt_pk_bf16_f32 v74, v170, v171
    v_and_b32 v8, s3, v63
    v_lshlrev_b32 v9, 16, v63
    v_and_b32 v10, s3, v62
    v_lshlrev_b32 v11, 16, v62
    v_fmac_f32 v172, v89, v8
    v_fmac_f32 v173, v89, v9
    v_fmac_f32 v174, v89, v10
    v_fmac_f32 v175, v89, v11
    v_add_f32 v172, v172, v188
    v_add_f32 v173, v173, v189
    v_add_f32 v174, v174, v190
    v_add_f32_e64 v175, v175, v191
    buffer_store_dwordx4 v[72:75], v27, s[36:39], s86 offen offset:2048 sc1
    v_cvt_pk_bf16_f32 v76, v172, v173
    v_cvt_pk_bf16_f32 v78, v174, v175
    buffer_store_dwordx4 v[76:79], v27, s[36:39], s86 offen offset:3072 sc1
    s_lshr_b32 s92, s83, 1
    s_lshl_b32 s92, s92, 3
    s_lshl_b32 s93, s79, 1
    s_add_u32 s92, s92, s93
    s_and_b32 s93, s83, 1
    s_add_u32 s92, s92, s93
    s_lshl_b32 s92, s92, 6
    s_add_u32 s101, s92, 4352
    buffer_load_dword v93, v94, s[36:39], s101 offen sc1
    s_waitcnt vmcnt(21)
    v_mfma_f32_32x32x16_bf16 v[192:207], a[0:3], a[112:115], 0
    buffer_load_dwordx4 a[184:187], v124, s[36:39], s68 offen offset:1024 sc1
    v_lshrrev_b32 v4, 3, v1
    v_and_b32 v5, 7, v1
    v_xor_b32 v6, v5, v4
    v_lshlrev_b32_e64 v6, 4, v6
    v_mfma_f32_32x32x16_bf16 v[208:223], a[0:3], a[116:119], 0
    s_lshl_b32 s96, s83, 6
    s_lshl_b32 s97, s78, 4
    s_add_u32 s96, s96, s97
    v_add_u32_e64 v7, s96, v4
    v_mul_u32_u24 v7, 896, v7
    v_mfma_f32_32x32x16_bf16 v[224:239], a[4:7], a[112:115], 0
    buffer_load_dwordx4 a[188:191], v125, s[36:39], s68 offen offset:1024 sc1
    s_lshl_b32 s97, s84, 7
    v_add3_u32 v16, v7, v6, s97
    v_add_u32 v18, 6144, v16
    s_lshl_b32 s96, s84, 6
    v_mfma_f32_32x32x16_bf16 v[240:255], a[4:7], a[116:119], 0
    s_lshl_b32 s97, s78, 4
    s_add_u32 s96, s96, s97
    v_lshrrev_b32 v6, 4, v1
    v_add_u32 v7, s96, v6
    s_waitcnt vmcnt(21)
    v_mfma_f32_32x32x16_bf16 v[192:207], a[8:11], a[120:123], v[192:207]
    buffer_load_dwordx4 a[192:195], v124, s[36:39], s69 offen offset:0 sc1
    v_lshlrev_b32 v7, 13, v7
    v_and_b32 v5, 15, v1
    v_lshl_add_u32 v17, v5, 4, v7
    v_lshrrev_b32_e64 v7, 5, v1
    v_mfma_f32_32x32x16_bf16 v[208:223], a[8:11], a[124:127], v[208:223]
    v_lshlrev_b32 v7, 6, v7
    v_lshlrev_b32 v5, 3, v5
    v_xor_b32_e64 v5, v5, v7
    v_lshl_add_u32 v6, v6, 7, v5
    s_add_u32 s96, s90, 2048
    v_mfma_f32_32x32x16_bf16 v[224:239], a[12:15], a[120:123], v[224:239]
    buffer_load_dwordx4 a[196:199], v125, s[36:39], s69 offen offset:0 sc1
    v_add_u32 v19, s96, v6
    v_lshrrev_b32 v6, 5, v1
    v_lshlrev_b32 v6, 9, v6
    v_and_b32 v7, 31, v1
    v_mfma_f32_32x32x16_bf16 v[240:255], a[12:15], a[124:127], v[240:255]
    v_lshl_add_u32 v24, v7, 2, v6
    v_and_b32 v4, 31, v1
    v_lshrrev_b32 v5, 5, v1
    s_lshl_b32 s96, s79, 1
    s_waitcnt vmcnt(21)
    v_mfma_f32_32x32x16_bf16 v[192:207], a[16:19], a[128:131], v[192:207]
    buffer_load_dwordx4 a[200:203], v124, s[36:39], s69 offen offset:1024 sc1
    v_lshrrev_b32 v6, 4, v4
    v_add_u32 v6, s96, v6
    v_lshlrev_b32 v6, 12, v6
    v_and_b32 v7, 15, v4
    v_mfma_f32_32x32x16_bf16 v[208:223], a[16:19], a[132:135], v[208:223]
    v_lshl_add_u32 v6, v7, 7, v6
    v_and_b32 v7, 7, v4
    s_lshl_b32 s96, s80, 2
    v_xor_b32_e64 v7, s96, v7
    v_lshl_add_u32 v7, v7, 4, v6
    v_mfma_f32_32x32x16_bf16 v[224:239], a[20:23], a[128:131], v[224:239]
    buffer_load_dwordx4 a[204:207], v125, s[36:39], s69 offen offset:1024 sc1
    v_lshl_add_u32 v7, v5, 3, v7
    v_mov_b32 v20, v7
    v_and_b32 v4, 3, v1
    v_bfe_u32 v5, v1, 2, 2
    v_mfma_f32_32x32x16_bf16 v[240:255], a[20:23], a[132:135], v[240:255]
    v_bfe_u32 v6, v1, 4, 1
    v_lshrrev_b32 v8, 5, v1
    v_lshrrev_b32 v7, 1, v5
    v_xor_b32 v7, s79, v7
    s_waitcnt vmcnt(21)
    v_mfma_f32_32x32x16_bf16 v[192:207], a[24:27], a[136:139], v[192:207]
    buffer_load_dwordx4 a[208:211], v124, s[36:39], s70 offen offset:0 sc1
    v_lshlrev_b32_e64 v7, 6, v7
    v_lshl_add_u32 v7, v6, 5, v7
    v_lshl_add_u32 v7, v4, 3, v7
    v_lshl_add_u32 v7, v5, 7, v7
    v_mfma_f32_32x32x16_bf16 v[208:223], a[24:27], a[140:143], v[208:223]
    v_lshl_add_u32 v7, v8, 9, v7
    s_lshl_b32 s96, s80, 13
    s_add_u32 s96, s96, 2048
    v_add_u32_e64 v21, s96, v7
    s_sub_u32 s96, s78, 1
    v_mfma_f32_32x32x16_bf16 v[224:239], a[28:31], a[136:139], v[224:239]
    buffer_load_dwordx4 a[212:215], v125, s[36:39], s70 offen offset:0 sc1
    s_and_b32 s96, s96, 3
    s_lshl_b32 s96, s96, 12
    s_add_u32 s96, s96, 81920
    v_add_u32_e64 v28, s96, v2
    v_mfma_f32_32x32x16_bf16 v[240:255], a[28:31], a[140:143], v[240:255]
    s_sub_u32 s96, s78, 2
    s_and_b32 s96, s96, 3
    s_lshl_b32 s96, s96, 12
    s_add_u32 s96, s96, 98304
    s_waitcnt vmcnt(21)
    v_mfma_f32_32x32x16_bf16 v[192:207], a[32:35], a[144:147], v[192:207]
    buffer_load_dwordx4 a[216:219], v124, s[36:39], s70 offen offset:1024 sc1
    v_add_u32 v29, s96, v2
    s_sub_u32 s96, s78, 3
    s_and_b32 s96, s96, 3
    s_lshl_b32 s96, s96, 12
    v_mfma_f32_32x32x16_bf16 v[208:223], a[32:35], a[148:151], v[208:223]
    s_add_u32 s96, s96, 114688
    v_add_u32_e64 v30, s96, v2
    s_add_u32 s96, s90, 81920
    v_add_u32 v31, s96, v2
    v_xor_b32_e64 v72, 0, v20
    v_mfma_f32_32x32x16_bf16 v[224:239], a[36:39], a[144:147], v[224:239]
    buffer_load_dwordx4 a[220:223], v125, s[36:39], s70 offen offset:1024 sc1
    s_waitcnt vmcnt(10)
    v_cmp_ne_u32 vcc, s85, v93
    s_nop 3
    s_cmp_lg_u64 vcc, 0
    s_cbranch_scc1 L_slow_h1
L_back_h1:
    buffer_load_dwordx4 a[112:115], v126, s[36:39], 0 offen offset:0 sc1
    v_mfma_f32_32x32x16_bf16 v[240:255], a[36:39], a[148:151], v[240:255]
    v_xor_b32 v73, 16, v20
    v_xor_b32 v74, 32, v20
    v_xor_b32_e64 v75, 48, v20
    s_add_u32 s96, s90, 16384
    v_mfma_f32_32x32x16_bf16 v[192:207], a[40:43], a[152:155], v[192:207]
    v_add_u32_e64 v23, s96, v2
    v_mfma_f32_32x32x16_bf16 v[208:223], a[40:43], a[156:159], v[208:223]
    v_mfma_f32_32x32x16_bf16 v[224:239], a[44:47], a[152:155], v[224:239]
    buffer_load_dwordx4 a[116:119], v127, s[36:39], 0 offen offset:0 sc1
    v_mfma_f32_32x32x16_bf16 v[240:255], a[44:47], a[156:159], v[240:255]
    v_mfma_f32_32x32x16_bf16 v[192:207], a[48:51], a[160:163], v[192:207]
    buffer_load_dwordx4 a[120:123], v126, s[36:39], 0 offen offset:1024 sc1
    v_mfma_f32_32x32x16_bf16 v[208:223], a[48:51], a[164:167], v[208:223]
    v_mfma_f32_32x32x16_bf16 v[224:239], a[52:55], a[160:163], v[224:239]
    buffer_load_dwordx4 a[124:127], v127, s[36:39], 0 offen offset:1024 sc1
    v_mfma_f32_32x32x16_bf16 v[240:255], a[52:55], a[164:167], v[240:255]
    v_mfma_f32_32x32x16_bf16 v[192:207], a[56:59], a[168:171], v[192:207]
    buffer_load_dwordx4 a[128:131], v126, s[36:39], s65 offen offset:0 sc1
    v_mfma_f32_32x32x16_bf16 v[208:223], a[56:59], a[172:175], v[208:223]
    v_mfma_f32_32x32x16_bf16 v[224:239], a[60:63], a[168:171], v[224:239]
    buffer_load_dwordx4 a[132:135], v127, s[36:39], s65 offen offset:0 sc1
    v_mfma_f32_32x32x16_bf16 v[240:255], a[60:63], a[172:175], v[240:255]
    s_barrier
    v_mfma_f32_32x32x16_bf16 v[192:207], a[64:67], a[176:179], v[192:207]
    buffer_load_dwordx4 a[136:139], v126, s[36:39], s65 offen offset:1024 sc1
    v_mfma_f32_32x32x16_bf16 v[208:223], a[64:67], a[180:183], v[208:223]
    v_mfma_f32_32x32x16_bf16 v[224:239], a[68:71], a[176:179], v[224:239]
    buffer_load_dwordx4 a[140:143], v127, s[36:39], s65 offen offset:1024 sc1
    v_mfma_f32_32x32x16_bf16 v[240:255], a[68:71], a[180:183], v[240:255]
    s_waitcnt vmcnt(16)
    v_mfma_f32_32x32x16_bf16 v[192:207], a[72:75], a[184:187], v[192:207]
    buffer_load_dwordx4 a[144:147], v126, s[36:39], s66 offen offset:0 sc1
    v_mfma_f32_32x32x16_bf16 v[208:223], a[72:75], a[188:191], v[208:223]
    v_mfma_f32_32x32x16_bf16 v[224:239], a[76:79], a[184:187], v[224:239]
    buffer_load_dwordx4 a[148:151], v127, s[36:39], s66 offen offset:0 sc1
    v_mfma_f32_32x32x16_bf16 v[240:255], a[76:79], a[188:191], v[240:255]
    s_waitcnt vmcnt(16)
    v_mfma_f32_32x32x16_bf16 v[192:207], a[80:83], a[192:195], v[192:207]
    buffer_load_dwordx4 a[152:155], v126, s[36:39], s66 offen offset:1024 sc1
    v_mfma_f32_32x32x16_bf16 v[208:223], a[80:83], a[196:199], v[208:223]
    v_mfma_f32_32x32x16_bf16 v[224:239], a[84:87], a[192:195], v[224:239]
    buffer_load_dwordx4 a[156:159], v127, s[36:39], s66 offen offset:1024 sc1
    v_mfma_f32_32x32x16_bf16 v[240:255], a[84:87], a[196:199], v[240:255]
    s_waitcnt vmcnt(16)
    v_mfma_f32_32x32x16_bf16 v[192:207], a[88:91], a[200:203], v[192:207]
    buffer_load_dwordx4 a[160:163], v126, s[36:39], s67 offen offset:0 sc1
    v_mfma_f32_32x32x16_bf16 v[208:223], a[88:91], a[204:207], v[208:223]
    v_mfma_f32_32x32x16_bf16 v[224:239], a[92:95], a[200:203], v[224:239]
    buffer_load_dwordx4 a[164:167], v127, s[36:39], s67 offen offset:0 sc1
    v_mfma_f32_32x32x16_bf16 v[240:255], a[92:95], a[204:207], v[240:255]
    s_waitcnt vmcnt(16)
    v_mfma_f32_32x32x16_bf16 v[192:207], a[96:99], a[208:211], v[192:207]
    buffer_load_dwordx4 a[168:171], v126, s[36:39], s67 offen offset:1024 sc1
    v_mfma_f32_32x32x16_bf16 v[208:223], a[96:99], a[212:215], v[208:223]
    v_mfma_f32_32x32x16_bf16 v[224:239], a[100:103], a[208:211], v[224:239]
    buffer_load_dwordx4 a[172:175], v127, s[36:39], s67 offen offset:1024 sc1
    v_mfma_f32_32x32x16_bf16 v[240:255], a[100:103], a[212:215], v[240:255]
    s_waitcnt vmcnt(16)
    v_mfma_f32_32x32x16_bf16 v[192:207], a[104:107], a[216:219], v[192:207]
    ds_read_b64_tr_b16 v[144:145], v120 offset:0
    ds_read_b64_tr_b16 v[146:147], v120 offset:1024
    buffer_load_dwordx4 a[176:179], v126, s[36:39], s68 offen offset:0 sc1
    v_mfma_f32_32x32x16_bf16 v[208:223], a[104:107], a[220:223], v[208:223]
    ds_read_b64_tr_b16 v[148:149], v121 offset:0
    ds_read_b64_tr_b16 v[150:151], v121 offset:1024
    v_mfma_f32_32x32x16_bf16 v[224:239], a[108:111], a[216:219], v[224:239]
    buffer_load_dwordx4 a[180:183], v127, s[36:39], s68 offen offset:0 sc1
    v_mfma_f32_32x32x16_bf16 v[240:255], a[108:111], a[220:223], v[240:255]
    s_waitcnt vmcnt(16) lgkmcnt(2)
    v_mfma_f32_32x32x16_bf16 v[192:207], v[144:147], a[112:115], v[192:207]
    ds_read_b64_tr_b16 v[128:129], v120 offset:2048
    ds_read_b64_tr_b16 v[130:131], v120 offset:3072
    buffer_load_dwordx4 a[184:187], v126, s[36:39], s68 offen offset:1024 sc1
    v_mfma_f32_32x32x16_bf16 v[208:223], v[144:147], a[116:119], v[208:223]
    ds_read_b64_tr_b16 v[132:133], v121 offset:2048
    ds_read_b64_tr_b16 v[134:135], v121 offset:3072
    s_waitcnt lgkmcnt(4)
    v_mfma_f32_32x32x16_bf16 v[224:239], v[148:151], a[112:115], v[224:239]
    buffer_load_dwordx4 a[188:191], v127, s[36:39], s68 offen offset:1024 sc1
    v_mfma_f32_32x32x16_bf16 v[240:255], v[148:151], a[116:119], v[240:255]
    s_waitcnt vmcnt(16) lgkmcnt(2)
    v_mfma_f32_32x32x16_bf16 v[192:207], v[128:131], a[120:123], v[192:207]
    ds_read_b64_tr_b16 v[136:137], v120 offset:16384
    ds_read_b64_tr_b16 v[138:139], v120 offset:17408
    buffer_load_dwordx4 a[192:195], v126, s[36:39], s69 offen offset:0 sc1
    v_mfma_f32_32x32x16_bf16 v[208:223], v[128:131], a[124:127], v[208:223]
    ds_read_b64_tr_b16 v[140:141], v121 offset:16384
    ds_read_b64_tr_b16 v[142:143], v121 offset:17408
    s_waitcnt lgkmcnt(4)
    v_mfma_f32_32x32x16_bf16 v[224:239], v[132:135], a[120:123], v[224:239]
    buffer_load_dwordx4 a[196:199], v127, s[36:39], s69 offen offset:0 sc1
    v_mfma_f32_32x32x16_bf16 v[240:255], v[132:135], a[124:127], v[240:255]
    s_waitcnt vmcnt(16) lgkmcnt(2)
    v_mfma_f32_32x32x16_bf16 v[192:207], v[136:139], a[128:131], v[192:207]
    ds_read_b64_tr_b16 v[144:145], v120 offset:18432
    ds_read_b64_tr_b16 v[146:147], v120 offset:19456
    buffer_load_dwordx4 a[200:203], v126, s[36:39], s69 offen offset:1024 sc1
    v_mfma_f32_32x32x16_bf16 v[208:223], v[136:139], a[132:135], v[208:223]
    ds_read_b64_tr_b16 v[148:149], v121 offset:18432
    ds_read_b64_tr_b16 v[150:151], v121 offset:19456
    s_waitcnt lgkmcnt(4)
    v_mfma_f32_32x32x16_bf16 v[224:239], v[140:143], a[128:131], v[224:239]
    buffer_load_dwordx4 a[204:207], v127, s[36:39], s69 offen offset:1024 sc1
    v_mfma_f32_32x32x16_bf16 v[240:255], v[140:143], a[132:135], v[240:255]
    s_waitcnt vmcnt(16) lgkmcnt(2)
    v_mfma_f32_32x32x16_bf16 v[192:207], v[144:147], a[136:139], v[192:207]
    ds_read_b64_tr_b16 v[128:129], v120 offset:32768
    ds_read_b64_tr_b16 v[130:131], v120 offset:33792
    buffer_load_dwordx4 a[208:211], v126, s[36:39], s70 offen offset:0 sc1
    v_mfma_f32_32x32x16_bf16 v[208:223], v[144:147], a[140:143], v[208:223]
    ds_read_b64_tr_b16 v[132:133], v121 offset:32768
    ds_read_b64_tr_b16 v[134:135], v121 offset:33792
    s_waitcnt lgkmcnt(4)
    v_mfma_f32_32x32x16_bf16 v[224:239], v[148:151], a[136:139], v[224:239]
    buffer_load_dwordx4 a[212:215], v127, s[36:39], s70 offen offset:0 sc1
    v_mfma_f32_32x32x16_bf16 v[240:255], v[148:151], a[140:143], v[240:255]
    s_waitcnt vmcnt(16) lgkmcnt(2)
    v_mfma_f32_32x32x16_bf16 v[192:207], v[128:131], a[144:147], v[192:207]
    ds_read_b64_tr_b16 v[136:137], v120 offset:34816
    ds_read_b64_tr_b16 v[138:139], v120 offset:35840
    buffer_load_dwordx4 a[216:219], v126, s[36:39], s70 offen offset:1024 sc1
    v_mfma_f32_32x32x16_bf16 v[208:223], v[128:131], a[148:151], v[208:223]
    ds_read_b64_tr_b16 v[140:141], v121 offset:34816
    ds_read_b64_tr_b16 v[142:143], v121 offset:35840
    s_waitcnt lgkmcnt(4)
    v_mfma_f32_32x32x16_bf16 v[224:239], v[132:135], a[144:147], v[224:239]
    buffer_load_dwordx4 a[220:223], v127, s[36:39], s70 offen offset:1024 sc1
    s_lshl_b32 s89, s83, 8
    s_add_u32 s89, s89, 3145728
    v_mfma_f32_32x32x16_bf16 v[240:255], v[132:135], a[148:151], v[240:255]
    s_waitcnt vmcnt(16) lgkmcnt(2)
    v_mfma_f32_32x32x16_bf16 v[192:207], v[136:139], a[152:155], v[192:207]
    ds_read_b64_tr_b16 v[144:145], v120 offset:49152
    ds_read_b64_tr_b16 v[146:147], v120 offset:50176
    buffer_load_dwordx4 v[176:179], v17, s[36:39], s89 offen sc1
    s_add_u32 s89, s89, 32768
    v_mfma_f32_32x32x16_bf16 v[208:223], v[136:139], a[156:159], v[208:223]
    ds_read_b64_tr_b16 v[148:149], v121 offset:49152
    ds_read_b64_tr_b16 v[150:151], v121 offset:50176
    s_waitcnt lgkmcnt(4)
    v_mfma_f32_32x32x16_bf16 v[224:239], v[140:143], a[152:155], v[224:239]
    buffer_load_dwordx4 v[180:183], v17, s[36:39], s89 offen sc1
    s_add_u32 s89, s89, 32768
    v_mfma_f32_32x32x16_bf16 v[240:255], v[140:143], a[156:159], v[240:255]
    s_waitcnt vmcnt(16) lgkmcnt(2)
    v_mfma_f32_32x32x16_bf16 v[192:207], v[144:147], a[160:163], v[192:207]
    ds_read_b64_tr_b16 v[128:129], v120 offset:51200
    ds_read_b64_tr_b16 v[130:131], v120 offset:52224
    buffer_load_dwordx4 v[184:187], v17, s[36:39], s89 offen sc1
    s_add_u32 s89, s89, 32768
    v_mfma_f32_32x32x16_bf16 v[208:223], v[144:147], a[164:167], v[208:223]
    ds_read_b64_tr_b16 v[132:133], v121 offset:51200
    ds_read_b64_tr_b16 v[134:135], v121 offset:52224
    s_waitcnt lgkmcnt(4)
    v_mfma_f32_32x32x16_bf16 v[224:239], v[148:151], a[160:163], v[224:239]
    buffer_load_dwordx4 v[188:191], v17, s[36:39], s89 offen sc1
    s_add_u32 m0, s90, 0
    v_mfma_f32_32x32x16_bf16 v[240:255], v[148:151], a[164:167], v[240:255]
    s_waitcnt vmcnt(16) lgkmcnt(2)
    v_mfma_f32_32x32x16_bf16 v[192:207], v[128:131], a[168:171], v[192:207]
    ds_read_b64_tr_b16 v[136:137], v122 offset:0
    ds_read_b64_tr_b16 v[138:139], v122 offset:1024
    buffer_load_dwordx4 v16, s[4:7], 0 offen lds
    v_mfma_f32_32x32x16_bf16 v[208:223], v[128:131], a[172:175], v[208:223]
    ds_read_b64_tr_b16 v[140:141], v123 offset:0
    ds_read_b64_tr_b16 v[142:143], v123 offset:1024
    s_waitcnt lgkmcnt(4)
    v_mfma_f32_32x32x16_bf16 v[224:239], v[132:135], a[168:171], v[224:239]
    buffer_load_dwordx4 v18, s[4:7], 0 offen offset:1024 lds
    s_lshr_b32 s92, s83, 1
    s_mul_i32 s92, s92, 14336
    s_and_b32 s93, s83, 1
    s_lshl_b32 s93, s93, 8
    v_mfma_f32_32x32x16_bf16 v[240:255], v[132:135], a[172:175], v[240:255]
    s_add_u32 s92, s92, s93
    s_lshl_b32 s93, s79, 7
    s_add_u32 s92, s92, s93
    s_add_u32 s92, s92, 2883584
    s_waitcnt vmcnt(16) lgkmcnt(2)
    v_mfma_f32_32x32x16_bf16 v[192:207], v[136:139], a[176:179], v[192:207]
    ds_read_b64_tr_b16 v[144:145], v122 offset:2048
    ds_read_b64_tr_b16 v[146:147], v122 offset:3072
    buffer_load_dword v96, v24, s[36:39], s92 offen offset:0 sc1
    buffer_load_dword v97, v24, s[36:39], s92 offen offset:1024 sc1
    v_mfma_f32_32x32x16_bf16 v[208:223], v[136:139], a[180:183], v[208:223]
    ds_read_b64_tr_b16 v[148:149], v123 offset:2048
    ds_read_b64_tr_b16 v[150:151], v123 offset:3072
    buffer_load_dword v98, v24, s[36:39], s92 offen offset:2048 sc1
    buffer_load_dword v99, v24, s[36:39], s92 offen offset:3072 sc1
    s_add_u32 s92, s92, 4096
    s_waitcnt lgkmcnt(4)
    v_mfma_f32_32x32x16_bf16 v[224:239], v[140:143], a[176:179], v[224:239]
    buffer_load_dword v100, v24, s[36:39], s92 offen offset:0 sc1
    buffer_load_dword v101, v24, s[36:39], s92 offen offset:1024 sc1
    v_mfma_f32_32x32x16_bf16 v[240:255], v[140:143], a[180:183], v[240:255]
    buffer_load_dword v102, v24, s[36:39], s92 offen offset:2048 sc1
    buffer_load_dword v103, v24, s[36:39], s92 offen offset:3072 sc1
    s_add_u32 s92, s92, 4096
    s_waitcnt vmcnt(22) lgkmcnt(2)
    v_mfma_f32_32x32x16_bf16 v[192:207], v[144:147], a[184:187], v[192:207]
    ds_read_b64_tr_b16 v[128:129], v122 offset:16384
    ds_read_b64_tr_b16 v[130:131], v122 offset:17408
    buffer_load_dword v104, v24, s[36:39], s92 offen offset:0 sc1
    buffer_load_dword v105, v24, s[36:39], s92 offen offset:1024 sc1
    v_mfma_f32_32x32x16_bf16 v[208:223], v[144:147], a[188:191], v[208:223]
    ds_read_b64_tr_b16 v[132:133], v123 offset:16384
    ds_read_b64_tr_b16 v[134:135], v123 offset:17408
    buffer_load_dword v106, v24, s[36:39], s92 offen offset:2048 sc1
    buffer_load_dword v107, v24, s[36:39], s92 offen offset:3072 sc1
    s_add_u32 s92, s92, 4096
    s_waitcnt lgkmcnt(4)
    v_mfma_f32_32x32x16_bf16 v[224:239], v[148:151], a[184:187], v[224:239]
    buffer_load_dword v108, v24, s[36:39], s92 offen offset:0 sc1
    buffer_load_dword v109, v24, s[36:39], s92 offen offset:1024 sc1
    v_mfma_f32_32x32x16_bf16 v[240:255], v[148:151], a[188:191], v[240:255]
    s_waitcnt vmcnt(26) lgkmcnt(2)
    v_mfma_f32_32x32x16_bf16 v[192:207], v[128:131], a[192:195], v[192:207]
    ds_read_b64_tr_b16 v[136:137], v122 offset:18432
    ds_read_b64_tr_b16 v[138:139], v122 offset:19456
    v_mfma_f32_32x32x16_bf16 v[208:223], v[128:131], a[196:199], v[208:223]
    ds_read_b64_tr_b16 v[140:141], v123 offset:18432
    ds_read_b64_tr_b16 v[142:143], v123 offset:19456
    s_waitcnt lgkmcnt(4)
    v_mfma_f32_32x32x16_bf16 v[224:239], v[132:135], a[192:195], v[224:239]
    v_mfma_f32_32x32x16_bf16 v[240:255], v[132:135], a[196:199], v[240:255]
    s_waitcnt vmcnt(24) lgkmcnt(2)
    v_mfma_f32_32x32x16_bf16 v[192:207], v[136:139], a[200:203], v[192:207]
    ds_read_b64_tr_b16 v[144:145], v122 offset:32768
    ds_read_b64_tr_b16 v[146:147], v122 offset:33792
    v_mfma_f32_32x32x16_bf16 v[208:223], v[136:139], a[204:207], v[208:223]
    ds_read_b64_tr_b16 v[148:149], v123 offset:32768
    ds_read_b64_tr_b16 v[150:151], v123 offset:33792
    s_waitcnt lgkmcnt(4)
    v_mfma_f32_32x32x16_bf16 v[224:239], v[140:143], a[200:203], v[224:239]
    v_mfma_f32_32x32x16_bf16 v[240:255], v[140:143], a[204:207], v[240:255]
    s_waitcnt vmcnt(19)
    v_xor_b32 v4, s85, v177
    v_xor_b32 v5, s85, v179
    s_waitcnt vmcnt(18)
    v_xor_b32 v6, s85, v181
    v_xor_b32_e64 v7, s85, v183
    s_waitcnt lgkmcnt(2)
    v_mfma_f32_32x32x16_bf16 v[192:207], v[144:147], a[208:211], v[192:207]
    ds_read_b64_tr_b16 v[128:129], v122 offset:34816
    ds_read_b64_tr_b16 v[130:131], v122 offset:35840
    v_or3_b32 v8, v4, v5, v6
    v_or_b32 v8, v8, v7
    s_waitcnt vmcnt(17)
    v_xor_b32_e64 v4, s85, v185
    v_mfma_f32_32x32x16_bf16 v[208:223], v[144:147], a[212:215], v[208:223]
    ds_read_b64_tr_b16 v[132:133], v123 offset:34816
    ds_read_b64_tr_b16 v[134:135], v123 offset:35840
    v_xor_b32 v5, s85, v187
    s_waitcnt vmcnt(16)
    v_xor_b32 v6, s85, v189
    v_xor_b32_e64 v7, s85, v191
    s_waitcnt lgkmcnt(4)
    v_mfma_f32_32x32x16_bf16 v[224:239], v[148:151], a[208:211], v[224:239]
    v_or3_b32 v8, v8, v4, v5
    v_or3_b32 v8, v8, v6, v7
    v_cmp_ne_u32 vcc, 0, v8
    s_nop 3
    s_cmp_lg_u64 vcc, 0
    s_cbranch_scc1 L_slow_y
L_back_y:
    v_mov_b32_e64 v177, v178
    v_mfma_f32_32x32x16_bf16 v[240:255], v[148:151], a[212:215], v[240:255]
    v_mov_b32 v181, v182
    v_mov_b32 v185, v186
    v_mov_b32_e64 v189, v190
    ds_write_b64 v19, v[176:177] offset:0
    s_waitcnt lgkmcnt(3)
    v_mfma_f32_32x32x16_bf16 v[192:207], v[128:131], a[216:219], v[192:207]
    ds_write_b64 v19, v[180:181] offset:512
    ds_write_b64 v19, v[184:185] offset:1024
    ds_write_b64 v19, v[188:189] offset:1536
    v_mfma_f32_32x32x16_bf16 v[208:223], v[128:131], a[220:223], v[208:223]
    s_waitcnt lgkmcnt(4)
    v_mfma_f32_32x32x16_bf16 v[224:239], v[132:135], a[216:219], v[224:239]
    v_mfma_f32_32x32x16_bf16 v[240:255], v[132:135], a[220:223], v[240:255]
    s_waitcnt vmcnt(12)
    v_add_f32 v96, v96, v97
    s_waitcnt vmcnt(11)
    v_add_f32 v96, v96, v98
    s_waitcnt vmcnt(10)
    v_add_f32 v96, v96, v99
    s_waitcnt vmcnt(9)
    v_add_f32 v96, v96, v100
    s_waitcnt vmcnt(8)
    v_add_f32 v96, v96, v101
    s_waitcnt vmcnt(7)
    v_add_f32 v96, v96, v102
    s_waitcnt vmcnt(6)
    v_add_f32 v96, v96, v103
    s_waitcnt vmcnt(5)
    v_add_f32 v96, v96, v104
    s_waitcnt vmcnt(4)
    v_add_f32 v96, v96, v105
    s_waitcnt vmcnt(3)
    v_add_f32 v96, v96, v106
    s_waitcnt vmcnt(2)
    v_add_f32 v96, v96, v107
    s_waitcnt vmcnt(1)
    v_add_f32 v96, v96, v108
    s_waitcnt vmcnt(0)
    v_add_f32 v96, v96, v109
    v_mov_b32_e64 v97, v96
    s_mov_b32 s96, 0x3b124925
    s_nop 0
    v_permlane32_swap_b32 v96, v97
    v_mul_f32 v96, s96, v96
    v_mul_f32 v97, s96, v97
    v_fma_f32 v97, -v96, v96, v97
    v_max_f32_e64 v97, 0, v97
    v_cvt_pk_bf16_f32 v98, v96, v97
    v_lshlrev_b32 v96, 16, v98
    v_and_b32 v97, s3, v98
    v_add_f32 v97, 0x3727c5ac, v97
    v_cvt_pk_bf16_f32 v97, v97, v97
    v_lshlrev_b32 v97, 16, v97
    v_sqrt_f32_e64 v97, v97
    s_nop 0
    v_cvt_pk_bf16_f32 v97, v97, v97
    v_lshlrev_b32 v97, 16, v97
    v_rcp_f32 v97, v97
    s_nop 0
    v_mul_f32 v98, v97, v97
    s_nop 7
    s_nop 3
    s_cmp_lg_u32 s78, 0
    s_cbranch_scc1 L_red_0
    ds_write_b128 v31, v[208:211] offset:0
    ds_write_b128 v31, v[212:215] offset:1024
    ds_write_b128 v31, v[216:219] offset:2048
    ds_write_b128 v31, v[220:223] offset:3072
    ds_write_b128 v31, v[224:227] offset:16384
    ds_write_b128 v31, v[228:231] offset:17408
    ds_write_b128 v31, v[232:235] offset:18432
    ds_write_b128 v31, v[236:239] offset:19456
    ds_write_b128 v31, v[240:243] offset:32768
    ds_write_b128 v31, v[244:247] offset:33792
    ds_write_b128 v31, v[248:251] offset:34816
    ds_write_b128 v31, v[252:255] offset:35840
    v_mov_b32 v56, v192
    v_mov_b32 v57, v193
    v_mov_b32 v58, v194
    v_mov_b32 v59, v195
    v_mov_b32 v60, v196
    v_mov_b32 v61, v197
    v_mov_b32 v62, v198
    v_mov_b32 v63, v199
    v_mov_b32 v64, v200
    v_mov_b32 v65, v201
    v_mov_b32 v66, v202
    v_mov_b32 v67, v203
    v_mov_b32 v68, v204
    v_mov_b32 v69, v205
    v_mov_b32 v70, v206
    v_mov_b32_e64 v71, v207
    s_branch L_red_done
L_red_0:
    s_cmp_lg_u32 s78, 1
    s_cbranch_scc1 L_red_1
    ds_write_b128 v31, v[192:195] offset:32768
    ds_write_b128 v31, v[196:199] offset:33792
    ds_write_b128 v31, v[200:203] offset:34816
    ds_write_b128 v31, v[204:207] offset:35840
    ds_write_b128 v31, v[224:227] offset:0
    ds_write_b128 v31, v[228:231] offset:1024
    ds_write_b128 v31, v[232:235] offset:2048
    ds_write_b128 v31, v[236:239] offset:3072
    ds_write_b128 v31, v[240:243] offset:16384
    ds_write_b128 v31, v[244:247] offset:17408
    ds_write_b128 v31, v[248:251] offset:18432
    ds_write_b128 v31, v[252:255] offset:19456
    v_mov_b32 v56, v208
    v_mov_b32 v57, v209
    v_mov_b32 v58, v210
    v_mov_b32 v59, v211
    v_mov_b32 v60, v212
    v_mov_b32 v61, v213
    v_mov_b32 v62, v214
    v_mov_b32 v63, v215
    v_mov_b32 v64, v216
    v_mov_b32 v65, v217
    v_mov_b32 v66, v218
    v_mov_b32 v67, v219
    v_mov_b32 v68, v220
    v_mov_b32 v69, v221
    v_mov_b32 v70, v222
    v_mov_b32_e64 v71, v223
    s_branch L_red_done
L_red_1:
    s_cmp_lg_u32 s78, 2
    s_cbranch_scc1 L_red_2
    ds_write_b128 v31, v[192:195] offset:16384
    ds_write_b128 v31, v[196:199] offset:17408
    ds_write_b128 v31, v[200:203] offset:18432
    ds_write_b128 v31, v[204:207] offset:19456
    ds_write_b128 v31, v[208:211] offset:32768
    ds_write_b128 v31, v[212:215] offset:33792
    ds_write_b128 v31, v[216:219] offset:34816
    ds_write_b128 v31, v[220:223] offset:35840
    ds_write_b128 v31, v[240:243] offset:0
    ds_write_b128 v31, v[244:247] offset:1024
    ds_write_b128 v31, v[248:251] offset:2048
    ds_write_b128 v31, v[252:255] offset:3072
    v_mov_b32 v56, v224
    v_mov_b32 v57, v225
    v_mov_b32 v58, v226
    v_mov_b32 v59, v227
    v_mov_b32 v60, v228
    v_mov_b32 v61, v229
    v_mov_b32 v62, v230
    v_mov_b32 v63, v231
    v_mov_b32 v64, v232
    v_mov_b32 v65, v233
    v_mov_b32 v66, v234
    v_mov_b32 v67, v235
    v_mov_b32 v68, v236
    v_mov_b32 v69, v237
    v_mov_b32 v70, v238
    v_mov_b32_e64 v71, v239
    s_branch L_red_done
L_red_2:
    s_cmp_lg_u32 s78, 3
    s_cbranch_scc1 L_red_3
    ds_write_b128 v31, v[192:195] offset:0
    ds_write_b128 v31, v[196:199] offset:1024
    ds_write_b128 v31, v[200:203] offset:2048
    ds_write_b128 v31, v[204:207] offset:3072
    ds_write_b128 v31, v[208:211] offset:16384
    ds_write_b128 v31, v[212:215] offset:17408
    ds_write_b128 v31, v[216:219] offset:18432
    ds_write_b128 v31, v[220:223] offset:19456
    ds_write_b128 v31, v[224:227] offset:32768
    ds_write_b128 v31, v[228:231] offset:33792
    ds_write_b128 v31, v[232:235] offset:34816
    ds_write_b128 v31, v[236:239] offset:35840
    v_mov_b32 v56, v240
    v_mov_b32 v57, v241
    v_mov_b32 v58, v242
    v_mov_b32 v59, v243
    v_mov_b32 v60, v244
    v_mov_b32 v61, v245
    v_mov_b32 v62, v246
    v_mov_b32 v63, v247
    v_mov_b32 v64, v248
    v_mov_b32 v65, v249
    v_mov_b32 v66, v250
    v_mov_b32 v67, v251
    v_mov_b32 v68, v252
    v_mov_b32 v69, v253
    v_mov_b32 v70, v254
    v_mov_b32 v71, v255
L_red_3:
L_red_done:
    s_waitcnt lgkmcnt(0)
    s_barrier
    ds_read_b128 v[192:195], v28 offset:0
    ds_read_b128 v[196:199], v28 offset:1024
    ds_read_b128 v[200:203], v28 offset:2048
    ds_read_b128 v[204:207], v28 offset:3072
    ds_read_b128 v[208:211], v29 offset:0
    ds_read_b128 v[212:215], v29 offset:1024
    ds_read_b128 v[216:219], v29 offset:2048
    ds_read_b128 v[220:223], v29 offset:3072
    ds_read_b128 v[224:227], v30 offset:0
    ds_read_b128 v[228:231], v30 offset:1024
    ds_read_b128 v[232:235], v30 offset:2048
    ds_read_b128 v[236:239], v30 offset:3072
    ds_read_b64 v[128:129], v72
    ds_read_b64_tr_b16 v[136:137], v21 offset:0
    ds_read_b64 v[130:131], v73
    ds_read_b64_tr_b16 v[138:139], v21 offset:1024
    ds_read_b64 v[132:133], v74
    ds_read_b64_tr_b16 v[140:141], v21 offset:4096
    ds_read_b64 v[134:135], v75
    ds_read_b64_tr_b16 v[142:143], v21 offset:5120
    v_add_f32 v56, v56, v192
    v_add_f32 v57, v57, v193
    v_add_f32 v58, v58, v194
    v_add_f32 v59, v59, v195
    v_add_f32 v60, v60, v196
    v_add_f32 v61, v61, v197
    v_add_f32 v62, v62, v198
    v_add_f32 v63, v63, v199
    v_add_f32 v64, v64, v200
    v_add_f32 v65, v65, v201
    v_add_f32 v66, v66, v202
    v_add_f32 v67, v67, v203
    v_add_f32 v68, v68, v204
    v_add_f32 v69, v69, v205
    v_add_f32 v70, v70, v206
    v_add_f32 v71, v71, v207
    v_add_f32 v56, v56, v208
    v_add_f32 v57, v57, v209
    v_add_f32 v58, v58, v210
    v_add_f32 v59, v59, v211
    s_waitcnt lgkmcnt(2)
    v_add_f32 v60, v60, v212
    v_add_f32 v61, v61, v213
    v_add_f32 v62, v62, v214
    v_add_f32 v63, v63, v215
    v_add_f32 v64, v64, v216
    v_add_f32 v65, v65, v217
    v_add_f32 v66, v66, v218
    v_add_f32 v67, v67, v219
    v_add_f32 v68, v68, v220
    v_add_f32 v69, v69, v221
    v_add_f32 v70, v70, v222
    v_add_f32 v71, v71, v223
    v_add_f32 v56, v56, v224
    v_add_f32 v57, v57, v225
    v_add_f32 v58, v58, v226
    v_add_f32 v59, v59, v227
    v_add_f32 v60, v60, v228
    v_add_f32 v61, v61, v229
    v_add_f32 v62, v62, v230
    v_add_f32 v63, v63, v231
    v_add_f32 v64, v64, v232
    v_add_f32 v65, v65, v233
    v_add_f32 v66, v66, v234
    v_add_f32 v67, v67, v235
    v_add_f32 v68, v68, v236
    v_add_f32 v69, v69, v237
    v_add_f32 v70, v70, v238
    v_add_f32 v71, v71, v239
    v_lshlrev_b32 v176, 16, v128
    v_lshlrev_b32 v180, 16, v136
    v_and_b32 v177, s3, v128
    v_and_b32 v181, s3, v136
    v_lshlrev_b32 v178, 16, v129
    v_lshlrev_b32 v182, 16, v137
    v_and_b32 v179, s3, v129
    v_and_b32 v183, s3, v137
    v_sub_f32 v184, v176, v96
    v_sub_f32 v185, v177, v96
    v_sub_f32 v186, v178, v96
    v_sub_f32 v187, v179, v96
    v_mul_f32 v184, v184, v97
    v_mul_f32 v185, v185, v97
    v_mul_f32 v186, v186, v97
    v_mul_f32 v187, v187, v97
    v_fmac_f32 v176, v184, v180
    v_fmac_f32 v177, v185, v181
    v_fmac_f32 v178, v186, v182
    v_fmac_f32 v179, v187, v183
    v_fmac_f32 v176, v98, v56
    v_fmac_f32 v177, v98, v57
    v_fmac_f32 v178, v98, v58
    v_fmac_f32_e64 v179, v98, v59
    v_cvt_pk_bf16_f32 v152, v176, v177
    v_cvt_pk_bf16_f32 v153, v178, v179
    ds_write_b64 v72, v[152:153] offset:16384
    v_lshlrev_b32 v176, 16, v130
    v_lshlrev_b32 v180, 16, v138
    v_and_b32 v177, s3, v130
    v_and_b32 v181, s3, v138
    v_lshlrev_b32 v178, 16, v131
    v_lshlrev_b32 v182, 16, v139
    v_and_b32 v179, s3, v131
    v_and_b32 v183, s3, v139
    v_sub_f32 v184, v176, v96
    v_sub_f32 v185, v177, v96
    v_sub_f32 v186, v178, v96
    v_sub_f32 v187, v179, v96
    v_mul_f32 v184, v184, v97
    v_mul_f32 v185, v185, v97
    v_mul_f32 v186, v186, v97
    v_mul_f32 v187, v187, v97
    v_fmac_f32 v176, v184, v180
    v_fmac_f32 v177, v185, v181
    v_fmac_f32 v178, v186, v182
    v_fmac_f32 v179, v187, v183
    v_fmac_f32 v176, v98, v60
    v_fmac_f32 v177, v98, v61
    v_fmac_f32 v178, v98, v62
    v_fmac_f32 v179, v98, v63
    v_cvt_pk_bf16_f32 v154, v176, v177
    v_cvt_pk_bf16_f32 v155, v178, v179
    ds_write_b64 v73, v[154:155] offset:16384
    v_lshlrev_b32 v176, 16, v132
    v_lshlrev_b32 v180, 16, v140
    v_and_b32 v177, s3, v132
    v_and_b32 v181, s3, v140
    v_lshlrev_b32 v178, 16, v133
    v_lshlrev_b32 v182, 16, v141
    v_and_b32 v179, s3, v133
    v_and_b32 v183, s3, v141
    v_sub_f32 v184, v176, v96
    v_sub_f32 v185, v177, v96
    v_sub_f32 v186, v178, v96
    v_sub_f32 v187, v179, v96
    v_mul_f32 v184, v184, v97
    v_mul_f32 v185, v185, v97
    v_mul_f32 v186, v186, v97
    v_mul_f32 v187, v187, v97
    v_fmac_f32 v176, v184, v180
    v_fmac_f32 v177, v185, v181
    v_fmac_f32 v178, v186, v182
    v_fmac_f32 v179, v187, v183
    v_fmac_f32 v176, v98, v64
    v_fmac_f32 v177, v98, v65
    v_fmac_f32 v178, v98, v66
    v_fmac_f32 v179, v98, v67
    v_cvt_pk_bf16_f32 v156, v176, v177
    v_cvt_pk_bf16_f32 v157, v178, v179
    ds_write_b64 v74, v[156:157] offset:16384
    s_waitcnt lgkmcnt(1)
    v_lshlrev_b32 v176, 16, v134
    v_lshlrev_b32 v180, 16, v142
    v_and_b32 v177, s3, v134
    v_and_b32 v181, s3, v142
    v_lshlrev_b32 v178, 16, v135
    v_lshlrev_b32 v182, 16, v143
    v_and_b32 v179, s3, v135
    v_and_b32 v183, s3, v143
    v_sub_f32 v184, v176, v96
    v_sub_f32 v185, v177, v96
    v_sub_f32 v186, v178, v96
    v_sub_f32 v187, v179, v96
    v_mul_f32 v184, v184, v97
    v_mul_f32 v185, v185, v97
    v_mul_f32 v186, v186, v97
    v_mul_f32 v187, v187, v97
    v_fmac_f32 v176, v184, v180
    v_fmac_f32 v177, v185, v181
    v_fmac_f32 v178, v186, v182
    v_fmac_f32 v179, v187, v183
    v_fmac_f32 v176, v98, v68
    v_fmac_f32 v177, v98, v69
    v_fmac_f32 v178, v98, v70
    v_fmac_f32_e64 v179, v98, v71
    v_cvt_pk_bf16_f32 v158, v176, v177
    v_cvt_pk_bf16_f32 v159, v178, v179
    ds_write_b64 v75, v[158:159] offset:16384
    s_waitcnt lgkmcnt(0)
    s_barrier
    ds_read_b128 v[160:163], v23
    ds_read_b128 v[164:167], v23 offset:1024
    v_add_u32 v18, 1024, v18
    s_waitcnt lgkmcnt(1)
    buffer_store_dwordx4 v[160:163], v16, s[32:35], 0 offen
    s_waitcnt lgkmcnt(0)
    buffer_store_dwordx4 v[164:167], v18, s[32:35], 0 offen
    s_waitcnt vmcnt(0)
L_end:
    s_endpgm
L_slow_nonce:
    s_mov_b32 s100, 0
    v_mov_b32_e64 v5, 0
L_spin_nonce:
    buffer_load_dword v90, v5, s[40:43], 0 offen sc1
    s_add_u32 s100, s100, 1
    s_waitcnt vmcnt(0)
    v_readfirstlane_b32 s85, v90
    s_cmp_gt_u32 s100, 200000
    s_cbranch_scc1 L_back_nonce
    s_nop 1
    s_cmp_eq_u32 s85, 0
    s_cbranch_scc1 L_spin_nonce
    s_branch L_back_nonce
L_slow_kv:
    s_mov_b32 s100, 0
L_spin_kv:
    buffer_load_dword v92, v91, s[36:39], s101 offen sc1
    s_add_u32 s100, s100, 1
    s_waitcnt vmcnt(0)
    v_cmp_ne_u32 vcc, s85, v92
    s_cmp_gt_u32 s100, 200000
    s_cbranch_scc1 L_back_kv
    s_nop 1
    s_cmp_lg_u64 vcc, 0
    s_cbranch_scc1 L_spin_kv
    s_branch L_back_kv
L_slow_h0:
    s_mov_b32 s100, 0
L_spin_h0:
    buffer_load_dword v92, v94, s[36:39], s101 offen sc1
    s_add_u32 s100, s100, 1
    s_waitcnt vmcnt(0)
    v_cmp_ne_u32 vcc, s85, v92
    s_cmp_gt_u32 s100, 200000
    s_cbranch_scc1 L_back_h0
    s_nop 1
    s_cmp_lg_u64 vcc, 0
    s_cbranch_scc1 L_spin_h0
    s_branch L_back_h0
L_slow_h1:
    s_mov_b32 s100, 0
L_spin_h1:
    buffer_load_dword v93, v94, s[36:39], s101 offen sc1
    s_add_u32 s100, s100, 1
    s_waitcnt vmcnt(0)
    v_cmp_ne_u32 vcc, s85, v93
    s_cmp_gt_u32 s100, 200000
    s_cbranch_scc1 L_back_h1
    s_nop 1
    s_cmp_lg_u64 vcc, 0
    s_cbranch_scc1 L_spin_h1
    s_branch L_back_h1
L_slow_y:
    s_mov_b32 s100, 0
L_spin_y:
    s_lshl_b32 s89, s83, 8
    s_add_u32 s89, s89, 3145728
    buffer_load_dwordx4 v[176:179], v17, s[36:39], s89 offen sc1
    s_add_u32 s89, s89, 32768
    buffer_load_dwordx4 v[180:183], v17, s[36:39], s89 offen sc1
    s_add_u32 s89, s89, 32768
    buffer_load_dwordx4 v[184:187], v17, s[36:39], s89 offen sc1
    s_add_u32 s89, s89, 32768
    buffer_load_dwordx4 v[188:191], v17, s[36:39], s89 offen sc1
    s_add_u32 s100, s100, 1
    s_waitcnt vmcnt(0)
    v_xor_b32 v4, s85, v177
    v_xor_b32 v5, s85, v179
    v_xor_b32 v6, s85, v181
    v_xor_b32 v7, s85, v183
    v_or3_b32 v8, v4, v5, v6
    v_or_b32 v8, v8, v7
    v_xor_b32 v4, s85, v185
    v_xor_b32 v5, s85, v187
    v_xor_b32 v6, s85, v189
    v_xor_b32_e64 v7, s85, v191
    v_or3_b32 v8, v8, v4, v5
    v_or3_b32 v8, v8, v6, v7
    v_cmp_ne_u32 vcc, 0, v8
    s_cmp_gt_u32 s100, 200000
    s_cbranch_scc1 L_back_y
    s_nop 1
    s_cmp_lg_u64 vcc, 0
    s_cbranch_scc1 L_spin_y
    s_branch L_back_y
L_helper:
    s_lshl_b32 s3, s2, 8
    v_add_u32 v1, s3, v0
    v_lshlrev_b32_e64 v1, 7, v1
    s_waitcnt lgkmcnt(0)
    s_mov_b32 s4, s48
    s_and_b32 s5, s49, 0xffff
    s_mov_b32 s6, 1835008
    s_mov_b32 s7, 0x20000
    s_mov_b32 s8, 0
    buffer_load_dword v2, v1, s[4:7], s8 offen
    s_mov_b32 s8, 1048576
    buffer_load_dword v3, v1, s[4:7], s8 offen
    s_mov_b32 s4, s62
    s_and_b32 s5, s63, 0xffff
    s_mov_b32 s6, 1605632
    s_mov_b32 s7, 0x20000
    s_mov_b32 s8, 0
    buffer_load_dword v4, v1, s[4:7], s8 offen
    s_mov_b32 s8, 1048576
    buffer_load_dword v5, v1, s[4:7], s8 offen
    s_mov_b32 s4, s64
    s_and_b32 s5, s65, 0xffff
    s_mov_b32 s6, 1605632
    s_mov_b32 s7, 0x20000
    s_mov_b32 s8, 0
    buffer_load_dword v6, v1, s[4:7], s8 offen
    s_mov_b32 s8, 1048576
    buffer_load_dword v7, v1, s[4:7], s8 offen
    s_mov_b32 s4, s56
    s_and_b32 s5, s57, 0xffff
    s_mov_b32 s6, 1835008
    s_mov_b32 s7, 0x20000
    s_mov_b32 s8, 0
    buffer_load_dword v8, v1, s[4:7], s8 offen
    s_mov_b32 s8, 1048576
    buffer_load_dword v9, v1, s[4:7], s8 offen
    s_mov_b32 s4, s66
    s_and_b32 s5, s67, 0xffff
    s_mov_b32 s6, 1605632
    s_mov_b32 s7, 0x20000
    s_mov_b32 s8, 0
    buffer_load_dword v10, v1, s[4:7], s8 offen
    s_mov_b32 s8, 1048576
    buffer_load_dword v11, v1, s[4:7], s8 offen
    s_waitcnt vmcnt(0)
    s_endpgm
L_code_end:
.section .rodata,"a"
.p2align 6
.amdhsa_kernel parallel_sum__ssm_conv_h3__glu_gated_reglu__prompt_kernel
  .amdhsa_next_free_vgpr 512
  .amdhsa_next_free_sgpr 102
  .amdhsa_accum_offset 256
  .amdhsa_group_segment_fixed_size 0
  .amdhsa_kernarg_size 104
  .amdhsa_user_sgpr_count 2
  .amdhsa_user_sgpr_kernarg_segment_ptr 1
  .amdhsa_system_sgpr_workgroup_id_x 1
.end_amdhsa_kernel
```
